```python
import torch

def _softmax(x, axis=-1):
    return torch.softmax(x, dim=axis)
def _gelu(x):
    return torch.nn.functional.gelu(x, approximate="tanh")
def _silu(x):
    return torch.nn.functional.silu(x)
def _sigmoid(x):
    return torch.sigmoid(x)
def _layernorm(x, axis=-1, eps=1e-5):
    m = x.mean(dim=axis, keepdim=True)
    v = x.var(dim=axis, keepdim=True, unbiased=False)
    return (x - m) / torch.sqrt(v + eps)
def _scatter_add(tgt, idx, src, axis=0):
    return tgt.clone().index_add_(axis, idx, src)
def _segment_sum(src, seg, n):
    out = torch.zeros((n,) + src.shape[1:], dtype=src.dtype)
    return out.index_add_(0, seg, src)
def _pad(x, pw):
    flat = tuple(v for pair in reversed(pw) for v in pair)
    return torch.nn.functional.pad(x, flat)

kernel_name = 'standalone__mha_softmax__near_ridge'

def setup_inputs():

    _w = (lambda a: (lambda t: t.to(torch.bfloat16) if t.is_floating_point() else t)(torch.as_tensor(a)))
    B, H, Sq, Sk, D = 8, 32, 256, 1024, 128
    return {
        "q": _w((lambda *s: torch.randn(*s, dtype=torch.bfloat16) * 0.8)(B, H, Sq, D)),
        "k": _w((lambda *s: torch.randn(*s, dtype=torch.bfloat16) * 0.8)(B, H, Sk, D)),
        "v": _w((lambda *s: torch.randn(*s, dtype=torch.bfloat16) * 0.05)(B, H, Sk, D)),
    }

def reference(q, k, v):
    scale = q.shape[-1] ** -0.5
    scores = torch.einsum("bhqd,bhkd->bhqk", q, k) * scale
    p = _softmax(scores, axis=-1)
    return torch.einsum("bhqk,bhkd->bhqd", p, v)
```

```asm
; @launch grid=(256,1,1) block=(256,1,1) lds=163840
.amdgcn_target "amdgcn-amd-amdhsa--gfx950"
.text
.globl standalone__mha_softmax__near_ridge_kernel
.p2align 12
.p2align 8
.type standalone__mha_softmax__near_ridge_kernel,@function
standalone__mha_softmax__near_ridge_kernel:
  s_cmp_ge_u32 s2, 256
  s_cbranch_scc1 L_end
  s_load_dwordx4 s[4:7], s[0:1], 0
  s_load_dwordx4 s[8:11], s[0:1], 16
  s_getpc_b64 s[44:45]
L_pc:
  s_add_u32 s44, s44, L_main-L_pc
  s_addc_u32 s45, s45, 0
  v_and_b32 v3, 7, v0
  v_lshlrev_b32 v3, 12, v3
  global_load_dword v60, v3, s[44:45]
  v_lshlrev_b32 v3, 4, v0
  global_load_dwordx4 v[60:63], v3, s[44:45]
  v_add_u32 v3, 0x1000, v3
  v_lshrrev_b32 v1, 6, v0
  v_and_b32 v2, 63, v0
  v_lshrrev_b32 v4, 4, v2
  v_and_b32 v5, 15, v2
  v_readfirstlane_b32 s3, v1
  v_lshlrev_b32 v31, 8, v4
  v_xor_b32 v30, v5, v4
  v_lshl_or_b32 v20, v30, 4, v31
  v_or_b32 v30, 4, v4
  v_xor_b32 v30, v5, v30
  v_lshl_or_b32 v21, v30, 4, v31
  v_or_b32 v30, 8, v4
  v_xor_b32 v30, v5, v30
  v_lshl_or_b32 v22, v30, 4, v31
  v_or_b32 v30, 12, v4
  v_xor_b32 v30, v5, v30
  v_lshl_or_b32 v23, v30, 4, v31
  s_lshl_b32 s34, s3, 14
  s_lshl_b32 s14, s2, 16
  s_lshl_b32 s15, s2, 18
  s_lshl_b32 s32, s3, 11
  s_and_b32 s35, s3, 1
  s_lshl_b32 s35, s35, 7
  v_xor_b32 v6, s35, v20
  v_xor_b32 v7, s35, v21
  s_mov_b32 s18, 65536
  s_mov_b32 s19, 0x20000
  s_mov_b32 s22, 262144
  s_mov_b32 s23, 0x20000
  s_getreg_b32 s52, hwreg(HW_REG_XCC_ID, 0, 3)
  s_lshl_b32 s52, s52, 1
  s_lshr_b32 s52, 0x2122, s52
  s_and_b32 s52, s52, 3
  s_waitcnt lgkmcnt(0)
  s_add_u32 s20, s6, s15
  s_addc_u32 s21, s7, 0
  s_mov_b32 m0, s32
  s_mov_b32 s46, s32
  buffer_load_dwordx4 v6, s[20:23], s46 offen offset:0 nt lds
  buffer_load_dwordx4 v7, s[20:23], s46 offen offset:1024 nt lds
  s_add_u32 s16, s4, s14
  s_addc_u32 s17, s5, 0
  s_add_u32 m0, s34, 98304
  s_mov_b32 s33, s34
  buffer_load_dwordx4 v20, s[16:19], s33 offen offset:0 nt lds
  buffer_load_dwordx4 v21, s[16:19], s33 offen offset:1024 nt lds
  buffer_load_dwordx4 v22, s[16:19], s33 offen offset:2048 nt lds
  buffer_load_dwordx4 v23, s[16:19], s33 offen offset:3072 nt lds
  s_cmp_lg_u32 s52, 0
  s_cbranch_scc1 L_narrow
  s_add_u32 m0, s34, 102400
  s_add_u32 s33, s34, 4096
  buffer_load_dwordx4 v20, s[16:19], s33 offen offset:0 nt lds
  buffer_load_dwordx4 v21, s[16:19], s33 offen offset:1024 nt lds
  buffer_load_dwordx4 v22, s[16:19], s33 offen offset:2048 nt lds
  buffer_load_dwordx4 v23, s[16:19], s33 offen offset:3072 nt lds
  s_add_u32 m0, s34, 106496
  s_add_u32 s33, s34, 8192
  buffer_load_dwordx4 v20, s[16:19], s33 offen offset:0 nt lds
  buffer_load_dwordx4 v21, s[16:19], s33 offen offset:1024 nt lds
  buffer_load_dwordx4 v22, s[16:19], s33 offen offset:2048 nt lds
  buffer_load_dwordx4 v23, s[16:19], s33 offen offset:3072 nt lds
  s_add_u32 m0, s34, 110592
  s_add_u32 s33, s34, 12288
  buffer_load_dwordx4 v20, s[16:19], s33 offen offset:0 nt lds
  buffer_load_dwordx4 v21, s[16:19], s33 offen offset:1024 nt lds
  buffer_load_dwordx4 v22, s[16:19], s33 offen offset:2048 nt lds
  buffer_load_dwordx4 v23, s[16:19], s33 offen offset:3072 nt lds
L_narrow:
  s_add_u32 s24, s8, s15
  s_addc_u32 s25, s9, 0
  s_mov_b32 s26, 262144
  s_mov_b32 s27, 0x20000
  s_add_u32 s28, s10, s14
  s_addc_u32 s29, s11, 0
  s_mov_b32 s30, 65536
  s_mov_b32 s31, 0x20000
  v_lshlrev_b32 v30, 1, v4
  v_xor_b32 v30, v5, v30
  v_lshl_or_b32 v24, v30, 4, v31
  v_lshlrev_b32 v30, 1, v4
  v_or_b32 v30, 8, v30
  v_xor_b32 v30, v5, v30
  v_lshl_or_b32 v25, v30, 4, v31
  v_xor_b32 v30, v4, v5
  v_lshlrev_b32 v30, 4, v30
  v_lshl_or_b32 v8, v5, 8, v30
  v_xor_b32 v9, 64, v8
  v_xor_b32 v10, 128, v8
  v_xor_b32 v11, 192, v8
  v_lshrrev_b32 v31, 2, v2
  v_and_b32 v30, 7, v31
  v_lshlrev_b32 v30, 5, v30
  v_lshl_or_b32 v30, v31, 8, v30
  v_and_b32 v31, 3, v2
  v_lshl_or_b32 v30, v31, 3, v30
  v_or_b32 v12, 65536, v30
  v_xor_b32 v13, 32, v12
  v_xor_b32 v14, 64, v12
  v_xor_b32 v15, 96, v12
  v_xor_b32 v16, 128, v12
  v_xor_b32 v17, 160, v12
  v_xor_b32 v18, 192, v12
  v_xor_b32 v19, 224, v12
  v_lshrrev_b32 v30, 1, v4
  v_xor_b32 v30, v30, v5
  v_lshlrev_b32 v30, 4, v30
  v_lshl_or_b32 v30, v5, 8, v30
  s_cmp_ge_u32 s3, 2
  s_cselect_b32 s47, 98304, 0
  s_add_u32 s47, s47, s34
  v_and_b32 v31, 1, v4
  v_lshl_or_b32 v30, v31, 3, v30
  v_add_u32 v128, s47, v30
  v_xor_b32 v129, 32, v128
  v_xor_b32 v130, 64, v128
  v_xor_b32 v131, 96, v128
  v_xor_b32 v132, 128, v128
  v_xor_b32 v133, 160, v128
  v_xor_b32 v134, 192, v128
  v_xor_b32 v135, 224, v128
  v_accvgpr_write_b32 a228, v128
  v_accvgpr_write_b32 a229, v129
  v_accvgpr_write_b32 a230, v130
  v_accvgpr_write_b32 a231, v131
  v_accvgpr_write_b32 a232, v132
  v_accvgpr_write_b32 a233, v133
  v_accvgpr_write_b32 a234, v134
  v_accvgpr_write_b32 a235, v135
  v_lshlrev_b32 v0, 4, v2
  s_mov_b32 s39, 0xc2000000
  s_mov_b32 s48, 0x3e0293ee
  s_mov_b32 s49, 0x3e0293ee
  s_mov_b32 s35, 0xffff0000
  v_and_b32 v5, 3, v5
  v_mov_b32 v30, 0x3f803f80
  v_cmp_eq_u32 vcc, 0, v5
  s_nop 1
  v_cndmask_b32 v30, 0, v30, vcc
  v_accvgpr_write_b32 a192, v30
  v_accvgpr_write_b32 a193, v30
  v_accvgpr_write_b32 a194, v30
  v_accvgpr_write_b32 a195, v30
  v_mov_b32 v30, 0x3f803f80
  v_cmp_gt_u32 vcc, 2, v5
  v_mov_b32 v1, 0x44444444
  v_mov_b32 v31, 0xeeeeeeee
  v_cndmask_b32 v30, 0, v30, vcc
  v_cmp_eq_u32 vcc, 1, v5
  v_accvgpr_write_b32 a236, v30
  v_accvgpr_write_b32 a237, v30
  v_accvgpr_write_b32 a238, v30
  v_accvgpr_write_b32 a239, v30
  v_cndmask_b32 v1, v1, v31, vcc
  v_mov_b32 v32, 0
  v_mov_b32 v33, 0
  v_mov_b32 v34, 0
  v_mov_b32 v35, 0
  v_mov_b32 v36, 0
  v_mov_b32 v37, 0
  v_mov_b32 v38, 0
  v_mov_b32 v39, 0
  v_mov_b32 v40, 0
  v_mov_b32 v41, 0
  v_mov_b32 v42, 0
  v_mov_b32 v43, 0
  v_mov_b32 v44, 0
  v_mov_b32 v45, 0
  v_mov_b32 v46, 0
  v_mov_b32 v47, 0
  s_mov_b32 s53, 0x8000
  s_add_u32 s54, s32, 32768
  s_add_u32 s55, s32, 98304
  s_add_u32 s42, s34, 98304
  v_add_u32 v52, s42, v8
  v_add_u32 v53, s42, v9
  v_add_u32 v54, s42, v10
  v_add_u32 v55, s42, v11
  v_add_u32 v4, s47, v20
  v_add_u32 v5, s47, v21
  v_add_u32 v30, s47, v22
  v_add_u32 v31, s47, v23
  s_waitcnt vmcnt(19)
  s_cmp_eq_u32 s52, 0
  s_cbranch_scc1 L_w0
  s_waitcnt vmcnt(7)
L_w0:
  s_mov_b64 exec, 0
  s_cmp_eq_u32 s3, 1
  s_cbranch_scc1 L_isl3
  s_cmp_eq_u32 s3, 2
  s_cbranch_scc1 L_isl4
  s_cmp_eq_u32 s3, 3
  s_cbranch_scc1 L_isl5
  s_cmp_lg_u32 s52, 0
  s_cbranch_scc1 L_isl1
  s_branch L_warm_done
.p2align 12
L_main:
  s_nop 0
L_warm_done:
  s_mov_b64 exec, -1
  s_cmp_eq_u32 s52, 0
  s_cbranch_scc1 L_wide
  s_cmp_lg_u32 s52, 1
  s_cbranch_scc1 L_thr1_1
  s_waitcnt vmcnt(4)
L_thr1_1:
  s_cmp_lg_u32 s52, 2
  s_cbranch_scc1 L_thr1_2
  s_waitcnt vmcnt(0)
L_thr1_2:
  s_add_u32 m0, s34, 102400
  s_add_u32 s33, s34, 4096
  buffer_load_dwordx4 v20, s[16:19], s33 offen offset:0 nt lds
  buffer_load_dwordx4 v21, s[16:19], s33 offen offset:1024 nt lds
  buffer_load_dwordx4 v22, s[16:19], s33 offen offset:2048 nt lds
  buffer_load_dwordx4 v23, s[16:19], s33 offen offset:3072 nt lds
  s_cmp_lg_u32 s52, 1
  s_cbranch_scc1 L_thr2_1
  s_waitcnt vmcnt(4)
L_thr2_1:
  s_cmp_lg_u32 s52, 2
  s_cbranch_scc1 L_thr2_2
  s_waitcnt vmcnt(0)
L_thr2_2:
  s_add_u32 m0, s34, 106496
  s_add_u32 s33, s34, 8192
  buffer_load_dwordx4 v20, s[16:19], s33 offen offset:0 nt lds
  buffer_load_dwordx4 v21, s[16:19], s33 offen offset:1024 nt lds
  buffer_load_dwordx4 v22, s[16:19], s33 offen offset:2048 nt lds
  buffer_load_dwordx4 v23, s[16:19], s33 offen offset:3072 nt lds
  s_cmp_lg_u32 s52, 1
  s_cbranch_scc1 L_thr3_1
  s_waitcnt vmcnt(4)
L_thr3_1:
  s_cmp_lg_u32 s52, 2
  s_cbranch_scc1 L_thr3_2
  s_waitcnt vmcnt(0)
L_thr3_2:
  s_add_u32 m0, s34, 110592
  s_add_u32 s33, s34, 12288
  buffer_load_dwordx4 v20, s[16:19], s33 offen offset:0 nt lds
  buffer_load_dwordx4 v21, s[16:19], s33 offen offset:1024 nt lds
  buffer_load_dwordx4 v22, s[16:19], s33 offen offset:2048 nt lds
  buffer_load_dwordx4 v23, s[16:19], s33 offen offset:3072 nt lds
L_wide:
  s_lshr_b32 s43, s2, 3
  s_and_b32 s43, s43, 3
  s_lshl_b32 s43, s43, 12
  v_add_u32 v3, s43, v3
  global_load_dwordx4 v[60:63], v3, s[44:45]
  v_add_u32 v3, 0x4000, v3
  global_load_dwordx4 v[60:63], v3, s[44:45]
  s_waitcnt vmcnt(18)
  s_barrier
  ds_read_b128 a[128:131], v8 offset:0
  ds_read_b128 a[132:135], v9 offset:0
  ds_read_b128 a[136:139], v10 offset:0
  ds_read_b128 a[140:143], v11 offset:0
  ds_read_b128 a[144:147], v8 offset:4096
  ds_read_b128 a[148:151], v9 offset:4096
  ds_read_b128 a[152:155], v10 offset:4096
  ds_read_b128 a[156:159], v11 offset:4096
  s_waitcnt vmcnt(14)
  ds_read_b128 v[96:99], v52 offset:0
  ds_read_b128 v[100:103], v53 offset:0
  ds_read_b128 v[104:107], v54 offset:0
  ds_read_b128 v[108:111], v55 offset:0
  s_waitcnt lgkmcnt(3)
  v_lshlrev_b32 v48, 16, v96
  v_and_b32 v49, s35, v96
  v_pk_mul_f32 v[48:49], v[48:49], s[48:49]
  v_cvt_pk_bf16_f32 v96, v48, v49
  v_lshlrev_b32 v50, 16, v97
  v_and_b32 v51, s35, v97
  v_pk_mul_f32 v[50:51], v[50:51], s[48:49]
  v_cvt_pk_bf16_f32 v97, v50, v51
  v_lshlrev_b32 v48, 16, v98
  v_and_b32 v49, s35, v98
  v_pk_mul_f32 v[48:49], v[48:49], s[48:49]
  v_cvt_pk_bf16_f32 v98, v48, v49
  v_lshlrev_b32 v50, 16, v99
  v_and_b32 v51, s35, v99
  v_pk_mul_f32 v[50:51], v[50:51], s[48:49]
  v_cvt_pk_bf16_f32 v99, v50, v51
  v_accvgpr_write_b32 a64, v96
  v_accvgpr_write_b32 a65, v97
  v_accvgpr_write_b32 a66, v98
  v_accvgpr_write_b32 a67, v99
  s_waitcnt lgkmcnt(2)
  v_lshlrev_b32 v48, 16, v100
  v_and_b32 v49, s35, v100
  v_pk_mul_f32 v[48:49], v[48:49], s[48:49]
  v_cvt_pk_bf16_f32 v100, v48, v49
  v_lshlrev_b32 v50, 16, v101
  v_and_b32 v51, s35, v101
  v_pk_mul_f32 v[50:51], v[50:51], s[48:49]
  v_cvt_pk_bf16_f32 v101, v50, v51
  v_lshlrev_b32 v48, 16, v102
  v_and_b32 v49, s35, v102
  v_pk_mul_f32 v[48:49], v[48:49], s[48:49]
  v_cvt_pk_bf16_f32 v102, v48, v49
  v_lshlrev_b32 v50, 16, v103
  v_and_b32 v51, s35, v103
  v_pk_mul_f32 v[50:51], v[50:51], s[48:49]
  v_cvt_pk_bf16_f32 v103, v50, v51
  v_accvgpr_write_b32 a68, v100
  v_accvgpr_write_b32 a69, v101
  v_accvgpr_write_b32 a70, v102
  v_accvgpr_write_b32 a71, v103
  v_mfma_f32_16x16x32_bf16 v[64:67], a[128:131], a[64:67], 0
  v_mfma_f32_16x16x32_bf16 v[68:71], a[144:147], a[64:67], 0
  s_waitcnt lgkmcnt(1)
  v_lshlrev_b32 v48, 16, v104
  v_and_b32 v49, s35, v104
  v_pk_mul_f32 v[48:49], v[48:49], s[48:49]
  v_cvt_pk_bf16_f32 v104, v48, v49
  v_lshlrev_b32 v50, 16, v105
  v_and_b32 v51, s35, v105
  v_pk_mul_f32 v[50:51], v[50:51], s[48:49]
  v_cvt_pk_bf16_f32 v105, v50, v51
  v_lshlrev_b32 v48, 16, v106
  v_and_b32 v49, s35, v106
  v_pk_mul_f32 v[48:49], v[48:49], s[48:49]
  v_cvt_pk_bf16_f32 v106, v48, v49
  v_lshlrev_b32 v50, 16, v107
  v_and_b32 v51, s35, v107
  v_pk_mul_f32 v[50:51], v[50:51], s[48:49]
  v_cvt_pk_bf16_f32 v107, v50, v51
  v_accvgpr_write_b32 a72, v104
  v_accvgpr_write_b32 a73, v105
  v_accvgpr_write_b32 a74, v106
  v_accvgpr_write_b32 a75, v107
  v_mfma_f32_16x16x32_bf16 v[64:67], a[132:135], a[68:71], v[64:67]
  v_mfma_f32_16x16x32_bf16 v[68:71], a[148:151], a[68:71], v[68:71]
  s_waitcnt lgkmcnt(0)
  v_lshlrev_b32 v48, 16, v108
  v_and_b32 v49, s35, v108
  v_pk_mul_f32 v[48:49], v[48:49], s[48:49]
  v_cvt_pk_bf16_f32 v108, v48, v49
  v_lshlrev_b32 v50, 16, v109
  v_and_b32 v51, s35, v109
  v_pk_mul_f32 v[50:51], v[50:51], s[48:49]
  v_cvt_pk_bf16_f32 v109, v50, v51
  v_lshlrev_b32 v48, 16, v110
  v_and_b32 v49, s35, v110
  v_pk_mul_f32 v[48:49], v[48:49], s[48:49]
  v_cvt_pk_bf16_f32 v110, v48, v49
  v_lshlrev_b32 v50, 16, v111
  v_and_b32 v51, s35, v111
  v_pk_mul_f32 v[50:51], v[50:51], s[48:49]
  v_cvt_pk_bf16_f32 v111, v50, v51
  v_accvgpr_write_b32 a76, v108
  v_accvgpr_write_b32 a77, v109
  v_accvgpr_write_b32 a78, v110
  v_accvgpr_write_b32 a79, v111
  v_mfma_f32_16x16x32_bf16 v[64:67], a[136:139], a[72:75], v[64:67]
  v_mfma_f32_16x16x32_bf16 v[68:71], a[152:155], a[72:75], v[68:71]
  s_nop 1
  v_mfma_f32_16x16x32_bf16 v[64:67], a[140:143], a[76:79], v[64:67]
  v_mfma_f32_16x16x32_bf16 v[68:71], a[156:159], a[76:79], v[68:71]
  s_waitcnt vmcnt(10)
  ds_read_b128 v[96:99], v52 offset:4096
  ds_read_b128 v[100:103], v53 offset:4096
  ds_read_b128 v[104:107], v54 offset:4096
  ds_read_b128 v[108:111], v55 offset:4096
  s_add_u32 m0, s32, 8192
  s_add_u32 s46, s46, 8192
  buffer_load_dwordx4 v6, s[20:23], s46 offen offset:0 nt lds
  buffer_load_dwordx4 v7, s[20:23], s46 offen offset:1024 nt lds
  s_nop 2
  v_max3_f32 v56, v64, v65, v66
  v_max3_f32 v56, v56, v67, v68
  v_max3_f32 v56, v56, v69, v70
  v_max_f32 v56, v56, v71
  v_mov_b32 v48, v56
  s_nop 1
  v_permlane16_swap_b32 v56, v48
  s_nop 1
  v_max_f32 v56, v56, v48
  v_mov_b32 v48, v56
  s_nop 1
  v_permlane32_swap_b32 v56, v48
  s_nop 1
  v_max_f32 v56, v56, v48
  v_sub_f32 v128, s39, v56
  v_mov_b32 v129, v128
  v_mov_b32 v130, v128
  v_mov_b32 v131, v128
  s_waitcnt lgkmcnt(3)
  v_lshlrev_b32 v48, 16, v96
  v_and_b32 v49, s35, v96
  v_pk_mul_f32 v[48:49], v[48:49], s[48:49]
  v_cvt_pk_bf16_f32 v96, v48, v49
  v_lshlrev_b32 v50, 16, v97
  v_and_b32 v51, s35, v97
  v_pk_mul_f32 v[50:51], v[50:51], s[48:49]
  v_cvt_pk_bf16_f32 v97, v50, v51
  v_lshlrev_b32 v48, 16, v98
  v_and_b32 v49, s35, v98
  v_pk_mul_f32 v[48:49], v[48:49], s[48:49]
  v_cvt_pk_bf16_f32 v98, v48, v49
  v_lshlrev_b32 v50, 16, v99
  v_and_b32 v51, s35, v99
  v_pk_mul_f32 v[50:51], v[50:51], s[48:49]
  v_cvt_pk_bf16_f32 v99, v50, v51
  v_accvgpr_write_b32 a80, v96
  v_accvgpr_write_b32 a81, v97
  v_accvgpr_write_b32 a82, v98
  v_accvgpr_write_b32 a83, v99
  s_waitcnt lgkmcnt(2)
  v_lshlrev_b32 v48, 16, v100
  v_and_b32 v49, s35, v100
  v_pk_mul_f32 v[48:49], v[48:49], s[48:49]
  v_cvt_pk_bf16_f32 v100, v48, v49
  v_lshlrev_b32 v50, 16, v101
  v_and_b32 v51, s35, v101
  v_pk_mul_f32 v[50:51], v[50:51], s[48:49]
  v_cvt_pk_bf16_f32 v101, v50, v51
  v_lshlrev_b32 v48, 16, v102
  v_and_b32 v49, s35, v102
  v_pk_mul_f32 v[48:49], v[48:49], s[48:49]
  v_cvt_pk_bf16_f32 v102, v48, v49
  v_lshlrev_b32 v50, 16, v103
  v_and_b32 v51, s35, v103
  v_pk_mul_f32 v[50:51], v[50:51], s[48:49]
  v_cvt_pk_bf16_f32 v103, v50, v51
  v_accvgpr_write_b32 a84, v100
  v_accvgpr_write_b32 a85, v101
  v_accvgpr_write_b32 a86, v102
  v_accvgpr_write_b32 a87, v103
  v_mfma_f32_16x16x32_bf16 v[72:75], a[128:131], a[80:83], 0
  v_mfma_f32_16x16x32_bf16 v[76:79], a[144:147], a[80:83], 0
  s_waitcnt lgkmcnt(1)
  v_lshlrev_b32 v48, 16, v104
  v_and_b32 v49, s35, v104
  v_pk_mul_f32 v[48:49], v[48:49], s[48:49]
  v_cvt_pk_bf16_f32 v104, v48, v49
  v_lshlrev_b32 v50, 16, v105
  v_and_b32 v51, s35, v105
  v_pk_mul_f32 v[50:51], v[50:51], s[48:49]
  v_cvt_pk_bf16_f32 v105, v50, v51
  v_lshlrev_b32 v48, 16, v106
  v_and_b32 v49, s35, v106
  v_pk_mul_f32 v[48:49], v[48:49], s[48:49]
  v_cvt_pk_bf16_f32 v106, v48, v49
  v_lshlrev_b32 v50, 16, v107
  v_and_b32 v51, s35, v107
  v_pk_mul_f32 v[50:51], v[50:51], s[48:49]
  v_cvt_pk_bf16_f32 v107, v50, v51
  v_accvgpr_write_b32 a88, v104
  v_accvgpr_write_b32 a89, v105
  v_accvgpr_write_b32 a90, v106
  v_accvgpr_write_b32 a91, v107
  v_mfma_f32_16x16x32_bf16 v[72:75], a[132:135], a[84:87], v[72:75]
  v_mfma_f32_16x16x32_bf16 v[76:79], a[148:151], a[84:87], v[76:79]
  s_waitcnt lgkmcnt(0)
  v_lshlrev_b32 v48, 16, v108
  v_and_b32 v49, s35, v108
  v_pk_mul_f32 v[48:49], v[48:49], s[48:49]
  v_cvt_pk_bf16_f32 v108, v48, v49
  v_lshlrev_b32 v50, 16, v109
  v_and_b32 v51, s35, v109
  v_pk_mul_f32 v[50:51], v[50:51], s[48:49]
  v_cvt_pk_bf16_f32 v109, v50, v51
  v_lshlrev_b32 v48, 16, v110
  v_and_b32 v49, s35, v110
  v_pk_mul_f32 v[48:49], v[48:49], s[48:49]
  v_cvt_pk_bf16_f32 v110, v48, v49
  v_lshlrev_b32 v50, 16, v111
  v_and_b32 v51, s35, v111
  v_pk_mul_f32 v[50:51], v[50:51], s[48:49]
  v_cvt_pk_bf16_f32 v111, v50, v51
  v_accvgpr_write_b32 a92, v108
  v_accvgpr_write_b32 a93, v109
  v_accvgpr_write_b32 a94, v110
  v_accvgpr_write_b32 a95, v111
  v_mfma_f32_16x16x32_bf16 v[72:75], a[136:139], a[88:91], v[72:75]
  v_mfma_f32_16x16x32_bf16 v[76:79], a[152:155], a[88:91], v[76:79]
  s_nop 1
  v_mfma_f32_16x16x32_bf16 v[72:75], a[140:143], a[92:95], v[72:75]
  v_mfma_f32_16x16x32_bf16 v[76:79], a[156:159], a[92:95], v[76:79]
  s_waitcnt vmcnt(8)
  ds_read_b128 v[96:99], v52 offset:8192
  ds_read_b128 v[100:103], v53 offset:8192
  ds_read_b128 v[104:107], v54 offset:8192
  ds_read_b128 v[108:111], v55 offset:8192
  s_add_u32 m0, s32, 16384
  s_add_u32 s46, s46, 8192
  buffer_load_dwordx4 v6, s[20:23], s46 offen offset:0 nt lds
  buffer_load_dwordx4 v7, s[20:23], s46 offen offset:1024 nt lds
  s_add_u32 m0, s32, 24576
  s_add_u32 s46, s46, 8192
  buffer_load_dwordx4 v6, s[20:23], s46 offen offset:0 nt lds
  buffer_load_dwordx4 v7, s[20:23], s46 offen offset:1024 nt lds
  s_nop 2
  v_max3_f32 v57, v72, v73, v74
  v_max3_f32 v57, v57, v75, v76
  v_max3_f32 v57, v57, v77, v78
  v_max_f32 v57, v57, v79
  v_mov_b32 v48, v57
  s_nop 1
  v_permlane16_swap_b32 v57, v48
  s_nop 1
  v_max_f32 v57, v57, v48
  v_mov_b32 v48, v57
  s_nop 1
  v_permlane32_swap_b32 v57, v48
  s_nop 1
  v_max_f32 v57, v57, v48
  v_sub_f32 v132, s39, v57
  v_mov_b32 v133, v132
  v_mov_b32 v134, v132
  v_mov_b32 v135, v132
  s_waitcnt lgkmcnt(3)
  v_lshlrev_b32 v48, 16, v96
  v_and_b32 v49, s35, v96
  v_pk_mul_f32 v[48:49], v[48:49], s[48:49]
  v_cvt_pk_bf16_f32 v96, v48, v49
  v_lshlrev_b32 v50, 16, v97
  v_and_b32 v51, s35, v97
  v_pk_mul_f32 v[50:51], v[50:51], s[48:49]
  v_cvt_pk_bf16_f32 v97, v50, v51
  v_lshlrev_b32 v48, 16, v98
  v_and_b32 v49, s35, v98
  v_pk_mul_f32 v[48:49], v[48:49], s[48:49]
  v_cvt_pk_bf16_f32 v98, v48, v49
  v_lshlrev_b32 v50, 16, v99
  v_and_b32 v51, s35, v99
  v_pk_mul_f32 v[50:51], v[50:51], s[48:49]
  v_cvt_pk_bf16_f32 v99, v50, v51
  v_accvgpr_write_b32 a96, v96
  v_accvgpr_write_b32 a97, v97
  v_accvgpr_write_b32 a98, v98
  v_accvgpr_write_b32 a99, v99
  s_waitcnt lgkmcnt(2)
  v_lshlrev_b32 v48, 16, v100
  v_and_b32 v49, s35, v100
  v_pk_mul_f32 v[48:49], v[48:49], s[48:49]
  v_cvt_pk_bf16_f32 v100, v48, v49
  v_lshlrev_b32 v50, 16, v101
  v_and_b32 v51, s35, v101
  v_pk_mul_f32 v[50:51], v[50:51], s[48:49]
  v_cvt_pk_bf16_f32 v101, v50, v51
  v_lshlrev_b32 v48, 16, v102
  v_and_b32 v49, s35, v102
  v_pk_mul_f32 v[48:49], v[48:49], s[48:49]
  v_cvt_pk_bf16_f32 v102, v48, v49
  v_lshlrev_b32 v50, 16, v103
  v_and_b32 v51, s35, v103
  v_pk_mul_f32 v[50:51], v[50:51], s[48:49]
  v_cvt_pk_bf16_f32 v103, v50, v51
  v_accvgpr_write_b32 a100, v100
  v_accvgpr_write_b32 a101, v101
  v_accvgpr_write_b32 a102, v102
  v_accvgpr_write_b32 a103, v103
  v_mfma_f32_16x16x32_bf16 v[80:83], a[128:131], a[96:99], 0
  v_mfma_f32_16x16x32_bf16 v[84:87], a[144:147], a[96:99], 0
  s_waitcnt lgkmcnt(1)
  v_lshlrev_b32 v48, 16, v104
  v_and_b32 v49, s35, v104
  v_pk_mul_f32 v[48:49], v[48:49], s[48:49]
  v_cvt_pk_bf16_f32 v104, v48, v49
  v_lshlrev_b32 v50, 16, v105
  v_and_b32 v51, s35, v105
  v_pk_mul_f32 v[50:51], v[50:51], s[48:49]
  v_cvt_pk_bf16_f32 v105, v50, v51
  v_lshlrev_b32 v48, 16, v106
  v_and_b32 v49, s35, v106
  v_pk_mul_f32 v[48:49], v[48:49], s[48:49]
  v_cvt_pk_bf16_f32 v106, v48, v49
  v_lshlrev_b32 v50, 16, v107
  v_and_b32 v51, s35, v107
  v_pk_mul_f32 v[50:51], v[50:51], s[48:49]
  v_cvt_pk_bf16_f32 v107, v50, v51
  v_accvgpr_write_b32 a104, v104
  v_accvgpr_write_b32 a105, v105
  v_accvgpr_write_b32 a106, v106
  v_accvgpr_write_b32 a107, v107
  v_mfma_f32_16x16x32_bf16 v[80:83], a[132:135], a[100:103], v[80:83]
  v_mfma_f32_16x16x32_bf16 v[84:87], a[148:151], a[100:103], v[84:87]
  s_waitcnt lgkmcnt(0)
  v_lshlrev_b32 v48, 16, v108
  v_and_b32 v49, s35, v108
  v_pk_mul_f32 v[48:49], v[48:49], s[48:49]
  v_cvt_pk_bf16_f32 v108, v48, v49
  v_lshlrev_b32 v50, 16, v109
  v_and_b32 v51, s35, v109
  v_pk_mul_f32 v[50:51], v[50:51], s[48:49]
  v_cvt_pk_bf16_f32 v109, v50, v51
  v_lshlrev_b32 v48, 16, v110
  v_and_b32 v49, s35, v110
  v_pk_mul_f32 v[48:49], v[48:49], s[48:49]
  v_cvt_pk_bf16_f32 v110, v48, v49
  v_lshlrev_b32 v50, 16, v111
  v_and_b32 v51, s35, v111
  v_pk_mul_f32 v[50:51], v[50:51], s[48:49]
  v_cvt_pk_bf16_f32 v111, v50, v51
  v_accvgpr_write_b32 a108, v108
  v_accvgpr_write_b32 a109, v109
  v_accvgpr_write_b32 a110, v110
  v_accvgpr_write_b32 a111, v111
  v_mfma_f32_16x16x32_bf16 v[80:83], a[136:139], a[104:107], v[80:83]
  v_mfma_f32_16x16x32_bf16 v[84:87], a[152:155], a[104:107], v[84:87]
  s_nop 1
  v_mfma_f32_16x16x32_bf16 v[80:83], a[140:143], a[108:111], v[80:83]
  v_mfma_f32_16x16x32_bf16 v[84:87], a[156:159], a[108:111], v[84:87]
  s_waitcnt vmcnt(8)
  ds_read_b128 v[96:99], v52 offset:12288
  ds_read_b128 v[100:103], v53 offset:12288
  ds_read_b128 v[104:107], v54 offset:12288
  ds_read_b128 v[108:111], v55 offset:12288
  s_add_u32 m0, s32, 65536
  s_mov_b32 s33, s32
  buffer_load_dwordx4 v24, s[24:27], s33 offen offset:0 nt lds
  buffer_load_dwordx4 v25, s[24:27], s33 offen offset:1024 nt lds
  s_add_u32 m0, s32, 73728
  s_add_u32 s33, s33, 8192
  buffer_load_dwordx4 v24, s[24:27], s33 offen offset:0 nt lds
  buffer_load_dwordx4 v25, s[24:27], s33 offen offset:1024 nt lds
  s_nop 2
  v_max3_f32 v58, v80, v81, v82
  v_max3_f32 v58, v58, v83, v84
  v_max3_f32 v58, v58, v85, v86
  v_max_f32 v58, v58, v87
  v_mov_b32 v48, v58
  s_nop 1
  v_permlane16_swap_b32 v58, v48
  s_nop 1
  v_max_f32 v58, v58, v48
  v_mov_b32 v48, v58
  s_nop 1
  v_permlane32_swap_b32 v58, v48
  s_nop 1
  v_max_f32 v58, v58, v48
  v_sub_f32 v136, s39, v58
  v_mov_b32 v137, v136
  v_mov_b32 v138, v136
  v_mov_b32 v139, v136
  s_waitcnt lgkmcnt(3)
  v_lshlrev_b32 v48, 16, v96
  v_and_b32 v49, s35, v96
  v_pk_mul_f32 v[48:49], v[48:49], s[48:49]
  v_cvt_pk_bf16_f32 v96, v48, v49
  v_lshlrev_b32 v50, 16, v97
  v_and_b32 v51, s35, v97
  v_pk_mul_f32 v[50:51], v[50:51], s[48:49]
  v_cvt_pk_bf16_f32 v97, v50, v51
  v_lshlrev_b32 v48, 16, v98
  v_and_b32 v49, s35, v98
  v_pk_mul_f32 v[48:49], v[48:49], s[48:49]
  v_cvt_pk_bf16_f32 v98, v48, v49
  v_lshlrev_b32 v50, 16, v99
  v_and_b32 v51, s35, v99
  v_pk_mul_f32 v[50:51], v[50:51], s[48:49]
  v_cvt_pk_bf16_f32 v99, v50, v51
  v_accvgpr_write_b32 a112, v96
  v_accvgpr_write_b32 a113, v97
  v_accvgpr_write_b32 a114, v98
  v_accvgpr_write_b32 a115, v99
  s_waitcnt lgkmcnt(2)
  v_lshlrev_b32 v48, 16, v100
  v_and_b32 v49, s35, v100
  v_pk_mul_f32 v[48:49], v[48:49], s[48:49]
  v_cvt_pk_bf16_f32 v100, v48, v49
  v_lshlrev_b32 v50, 16, v101
  v_and_b32 v51, s35, v101
  v_pk_mul_f32 v[50:51], v[50:51], s[48:49]
  v_cvt_pk_bf16_f32 v101, v50, v51
  v_lshlrev_b32 v48, 16, v102
  v_and_b32 v49, s35, v102
  v_pk_mul_f32 v[48:49], v[48:49], s[48:49]
  v_cvt_pk_bf16_f32 v102, v48, v49
  v_lshlrev_b32 v50, 16, v103
  v_and_b32 v51, s35, v103
  v_pk_mul_f32 v[50:51], v[50:51], s[48:49]
  v_cvt_pk_bf16_f32 v103, v50, v51
  v_accvgpr_write_b32 a116, v100
  v_accvgpr_write_b32 a117, v101
  v_accvgpr_write_b32 a118, v102
  v_accvgpr_write_b32 a119, v103
  v_mfma_f32_16x16x32_bf16 v[88:91], a[128:131], a[112:115], 0
  v_mfma_f32_16x16x32_bf16 v[92:95], a[144:147], a[112:115], 0
  s_waitcnt lgkmcnt(1)
  v_lshlrev_b32 v48, 16, v104
  v_and_b32 v49, s35, v104
  v_pk_mul_f32 v[48:49], v[48:49], s[48:49]
  v_cvt_pk_bf16_f32 v104, v48, v49
  v_lshlrev_b32 v50, 16, v105
  v_and_b32 v51, s35, v105
  v_pk_mul_f32 v[50:51], v[50:51], s[48:49]
  v_cvt_pk_bf16_f32 v105, v50, v51
  v_lshlrev_b32 v48, 16, v106
  v_and_b32 v49, s35, v106
  v_pk_mul_f32 v[48:49], v[48:49], s[48:49]
  v_cvt_pk_bf16_f32 v106, v48, v49
  v_lshlrev_b32 v50, 16, v107
  v_and_b32 v51, s35, v107
  v_pk_mul_f32 v[50:51], v[50:51], s[48:49]
  v_cvt_pk_bf16_f32 v107, v50, v51
  v_accvgpr_write_b32 a120, v104
  v_accvgpr_write_b32 a121, v105
  v_accvgpr_write_b32 a122, v106
  v_accvgpr_write_b32 a123, v107
  v_mfma_f32_16x16x32_bf16 v[88:91], a[132:135], a[116:119], v[88:91]
  v_mfma_f32_16x16x32_bf16 v[92:95], a[148:151], a[116:119], v[92:95]
  s_waitcnt lgkmcnt(0)
  v_lshlrev_b32 v48, 16, v108
  v_and_b32 v49, s35, v108
  v_pk_mul_f32 v[48:49], v[48:49], s[48:49]
  v_cvt_pk_bf16_f32 v108, v48, v49
  v_lshlrev_b32 v50, 16, v109
  v_and_b32 v51, s35, v109
  v_pk_mul_f32 v[50:51], v[50:51], s[48:49]
  v_cvt_pk_bf16_f32 v109, v50, v51
  v_lshlrev_b32 v48, 16, v110
  v_and_b32 v49, s35, v110
  v_pk_mul_f32 v[48:49], v[48:49], s[48:49]
  v_cvt_pk_bf16_f32 v110, v48, v49
  v_lshlrev_b32 v50, 16, v111
  v_and_b32 v51, s35, v111
  v_pk_mul_f32 v[50:51], v[50:51], s[48:49]
  v_cvt_pk_bf16_f32 v111, v50, v51
  v_accvgpr_write_b32 a124, v108
  v_accvgpr_write_b32 a125, v109
  v_accvgpr_write_b32 a126, v110
  v_accvgpr_write_b32 a127, v111
  v_mfma_f32_16x16x32_bf16 v[88:91], a[136:139], a[120:123], v[88:91]
  v_mfma_f32_16x16x32_bf16 v[92:95], a[152:155], a[120:123], v[92:95]
  s_nop 1
  v_mfma_f32_16x16x32_bf16 v[88:91], a[140:143], a[124:127], v[88:91]
  v_mfma_f32_16x16x32_bf16 v[92:95], a[156:159], a[124:127], v[92:95]
  s_waitcnt vmcnt(8)
  s_barrier
  ds_read_b128 a[128:131], v8 offset:8192
  ds_read_b128 a[132:135], v9 offset:8192
  ds_read_b128 a[136:139], v10 offset:8192
  ds_read_b128 a[140:143], v11 offset:8192
  ds_read_b128 a[144:147], v8 offset:12288
  ds_read_b128 a[148:151], v9 offset:12288
  ds_read_b128 a[152:155], v10 offset:12288
  ds_read_b128 a[156:159], v11 offset:12288
  v_max3_f32 v59, v88, v89, v90
  v_max3_f32 v59, v59, v91, v92
  v_max3_f32 v59, v59, v93, v94
  v_max_f32 v59, v59, v95
  v_mov_b32 v48, v59
  s_nop 1
  v_permlane16_swap_b32 v59, v48
  s_nop 1
  v_max_f32 v59, v59, v48
  v_mov_b32 v48, v59
  s_nop 1
  v_permlane32_swap_b32 v59, v48
  s_nop 1
  v_max_f32 v59, v59, v48
  v_sub_f32 v140, s39, v59
  v_mov_b32 v141, v140
  v_mov_b32 v142, v140
  v_mov_b32 v143, v140
  s_add_u32 m0, s32, 32768
  s_add_u32 s46, s46, 8192
  buffer_load_dwordx4 v6, s[20:23], s46 offen offset:0 nt lds
  buffer_load_dwordx4 v7, s[20:23], s46 offen offset:1024 nt lds
  s_add_u32 m0, s32, 40960
  s_add_u32 s46, s46, 8192
  buffer_load_dwordx4 v6, s[20:23], s46 offen offset:0 nt lds
  buffer_load_dwordx4 v7, s[20:23], s46 offen offset:1024 nt lds
  s_waitcnt lgkmcnt(0)
  v_mfma_f32_16x16x32_bf16 v[96:99], a[128:131], a[64:67], v[128:131]
  v_add_f32 v64, v64, v128
  v_add_f32 v65, v65, v128
  v_mfma_f32_16x16x32_bf16 v[96:99], a[132:135], a[68:71], v[96:99]
  v_add_f32 v66, v66, v128
  v_exp_f32 v26, v64
  v_mfma_f32_16x16x32_bf16 v[96:99], a[136:139], a[72:75], v[96:99]
  v_add_f32 v67, v67, v128
  v_exp_f32 v27, v65
  v_mfma_f32_16x16x32_bf16 v[96:99], a[140:143], a[76:79], v[96:99]
  v_add_f32 v68, v68, v128
  v_exp_f32 v28, v66
  v_mfma_f32_16x16x32_bf16 v[104:107], a[128:131], a[80:83], v[132:135]
  v_cvt_pk_bf16_f32 v160, v26, v27
  v_add_f32 v69, v69, v128
  v_mfma_f32_16x16x32_bf16 v[104:107], a[132:135], a[84:87], v[104:107]
  v_exp_f32 v29, v67
  v_add_f32 v70, v70, v128
  v_mfma_f32_16x16x32_bf16 v[104:107], a[136:139], a[88:91], v[104:107]
  v_exp_f32 v26, v68
  v_cvt_pk_bf16_f32 v161, v28, v29
  v_mfma_f32_16x16x32_bf16 v[104:107], a[140:143], a[92:95], v[104:107]
  v_add_f32 v71, v71, v128
  v_exp_f32 v27, v69
  v_mfma_f32_16x16x32_bf16 v[112:115], a[128:131], a[96:99], v[136:139]
  v_add_f32 v72, v72, v132
  v_exp_f32 v28, v70
  v_mfma_f32_16x16x32_bf16 v[112:115], a[132:135], a[100:103], v[112:115]
  v_cvt_pk_bf16_f32 v162, v26, v27
  v_add_f32 v73, v73, v132
  v_mfma_f32_16x16x32_bf16 v[112:115], a[136:139], a[104:107], v[112:115]
  v_exp_f32 v29, v71
  v_add_f32 v74, v74, v132
  v_mfma_f32_16x16x32_bf16 v[112:115], a[140:143], a[108:111], v[112:115]
  v_exp_f32 v26, v72
  v_cvt_pk_bf16_f32 v163, v28, v29
  v_mfma_f32_16x16x32_bf16 v[120:123], a[128:131], a[112:115], v[140:143]
  v_add_f32 v75, v75, v132
  v_exp_f32 v27, v73
  v_mfma_f32_16x16x32_bf16 v[120:123], a[132:135], a[116:119], v[120:123]
  v_add_f32 v76, v76, v132
  v_exp_f32 v28, v74
  v_mfma_f32_16x16x32_bf16 v[120:123], a[136:139], a[120:123], v[120:123]
  v_cvt_pk_bf16_f32 v168, v26, v27
  v_add_f32 v77, v77, v132
  v_mfma_f32_16x16x32_bf16 v[120:123], a[140:143], a[124:127], v[120:123]
  v_exp_f32 v29, v75
  v_add_f32 v78, v78, v132
  v_mfma_f32_16x16x32_bf16 v[100:103], a[144:147], a[64:67], v[128:131]
  v_exp_f32 v26, v76
  v_cvt_pk_bf16_f32 v169, v28, v29
  v_mfma_f32_16x16x32_bf16 v[100:103], a[148:151], a[68:71], v[100:103]
  v_add_f32 v79, v79, v132
  v_exp_f32 v27, v77
  v_mfma_f32_16x16x32_bf16 v[100:103], a[152:155], a[72:75], v[100:103]
  v_add_f32 v80, v80, v136
  v_exp_f32 v28, v78
  v_mfma_f32_16x16x32_bf16 v[100:103], a[156:159], a[76:79], v[100:103]
  v_cvt_pk_bf16_f32 v170, v26, v27
  v_add_f32 v81, v81, v136
  v_mfma_f32_16x16x32_bf16 v[108:111], a[144:147], a[80:83], v[132:135]
  v_exp_f32 v29, v79
  v_add_f32 v82, v82, v136
  v_mfma_f32_16x16x32_bf16 v[108:111], a[148:151], a[84:87], v[108:111]
  v_exp_f32 v26, v80
  v_cvt_pk_bf16_f32 v171, v28, v29
  v_mfma_f32_16x16x32_bf16 v[108:111], a[152:155], a[88:91], v[108:111]
  v_add_f32 v83, v83, v136
  v_exp_f32 v27, v81
  v_mfma_f32_16x16x32_bf16 v[108:111], a[156:159], a[92:95], v[108:111]
  v_add_f32 v84, v84, v136
  v_exp_f32 v28, v82
  v_mfma_f32_16x16x32_bf16 v[116:119], a[144:147], a[96:99], v[136:139]
  v_cvt_pk_bf16_f32 v176, v26, v27
  v_add_f32 v85, v85, v136
  v_mfma_f32_16x16x32_bf16 v[116:119], a[148:151], a[100:103], v[116:119]
  v_exp_f32 v29, v83
  v_add_f32 v86, v86, v136
  v_mfma_f32_16x16x32_bf16 v[116:119], a[152:155], a[104:107], v[116:119]
  v_exp_f32 v26, v84
  v_cvt_pk_bf16_f32 v177, v28, v29
  v_mfma_f32_16x16x32_bf16 v[116:119], a[156:159], a[108:111], v[116:119]
  v_add_f32 v87, v87, v136
  v_exp_f32 v27, v85
  v_mfma_f32_16x16x32_bf16 v[124:127], a[144:147], a[112:115], v[140:143]
  v_add_f32 v88, v88, v140
  v_exp_f32 v28, v86
  v_mfma_f32_16x16x32_bf16 v[124:127], a[148:151], a[116:119], v[124:127]
  v_cvt_pk_bf16_f32 v178, v26, v27
  v_add_f32 v89, v89, v140
  v_mfma_f32_16x16x32_bf16 v[124:127], a[152:155], a[120:123], v[124:127]
  v_exp_f32 v29, v87
  v_add_f32 v90, v90, v140
  v_mfma_f32_16x16x32_bf16 v[124:127], a[156:159], a[124:127], v[124:127]
  v_exp_f32 v26, v88
  v_cvt_pk_bf16_f32 v179, v28, v29
  s_waitcnt vmcnt(10)
  s_barrier
  ds_read_b128 a[128:131], v8 offset:16384
  ds_read_b128 a[132:135], v9 offset:16384
  ds_read_b128 a[136:139], v10 offset:16384
L_isl1:
  s_cbranch_execz L_isl2
  ds_read_b128 a[140:143], v11 offset:16384
  ds_read_b128 a[144:147], v8 offset:20480
  ds_read_b128 a[148:151], v9 offset:20480
  ds_read_b128 a[152:155], v10 offset:20480
  ds_read_b128 a[156:159], v11 offset:20480
  s_add_u32 m0, s32, 81920
  s_add_u32 s33, s33, 8192
  buffer_load_dwordx4 v24, s[24:27], s33 offen offset:0 nt lds
  buffer_load_dwordx4 v25, s[24:27], s33 offen offset:1024 nt lds
  s_add_u32 m0, s32, 90112
  s_add_u32 s33, s33, 8192
  buffer_load_dwordx4 v24, s[24:27], s33 offen offset:0 nt lds
  buffer_load_dwordx4 v25, s[24:27], s33 offen offset:1024 nt lds
  v_add_f32 v91, v91, v140
  v_exp_f32 v27, v89
  v_add_f32 v92, v92, v140
  v_exp_f32 v28, v90
  v_cvt_pk_bf16_f32 v184, v26, v27
  v_add_f32 v93, v93, v140
  v_exp_f32 v29, v91
  v_add_f32 v94, v94, v140
  v_exp_f32 v26, v92
  v_cvt_pk_bf16_f32 v185, v28, v29
  v_add_f32 v95, v95, v140
  v_exp_f32 v27, v93
  v_exp_f32 v28, v94
  v_cvt_pk_bf16_f32 v186, v26, v27
  v_exp_f32 v29, v95
  s_nop 0
  v_cvt_pk_bf16_f32 v187, v28, v29
  s_waitcnt lgkmcnt(0)
  v_mfma_f32_16x16x32_bf16 v[64:67], a[128:131], a[64:67], v[128:131]
  v_exp_f32 v26, v96
  v_exp_f32 v27, v97
  v_mfma_f32_16x16x32_bf16 v[64:67], a[132:135], a[68:71], v[64:67]
  v_exp_f32 v28, v98
  v_mfma_f32_16x16x32_bf16 v[64:67], a[136:139], a[72:75], v[64:67]
  v_cvt_pk_bf16_f32 v164, v26, v27
  v_exp_f32 v29, v99
  v_mfma_f32_16x16x32_bf16 v[64:67], a[140:143], a[76:79], v[64:67]
  v_exp_f32 v26, v100
  v_mfma_f32_16x16x32_bf16 v[72:75], a[128:131], a[80:83], v[132:135]
  v_cvt_pk_bf16_f32 v165, v28, v29
  v_exp_f32 v27, v101
  v_mfma_f32_16x16x32_bf16 v[72:75], a[132:135], a[84:87], v[72:75]
  v_exp_f32 v28, v102
  v_mfma_f32_16x16x32_bf16 v[72:75], a[136:139], a[88:91], v[72:75]
  v_cvt_pk_bf16_f32 v166, v26, v27
  v_exp_f32 v29, v103
  v_mfma_f32_16x16x32_bf16 v[72:75], a[140:143], a[92:95], v[72:75]
  v_exp_f32 v26, v104
  v_mfma_f32_16x16x32_bf16 v[80:83], a[128:131], a[96:99], v[136:139]
  v_cvt_pk_bf16_f32 v167, v28, v29
  v_exp_f32 v27, v105
  v_mfma_f32_16x16x32_bf16 v[80:83], a[132:135], a[100:103], v[80:83]
  v_exp_f32 v28, v106
  v_mfma_f32_16x16x32_bf16 v[80:83], a[136:139], a[104:107], v[80:83]
  v_cvt_pk_bf16_f32 v172, v26, v27
  v_exp_f32 v29, v107
  v_mfma_f32_16x16x32_bf16 v[80:83], a[140:143], a[108:111], v[80:83]
  v_exp_f32 v26, v108
  v_mfma_f32_16x16x32_bf16 v[88:91], a[128:131], a[112:115], v[140:143]
  v_cvt_pk_bf16_f32 v173, v28, v29
  v_exp_f32 v27, v109
  v_mfma_f32_16x16x32_bf16 v[88:91], a[132:135], a[116:119], v[88:91]
  v_exp_f32 v28, v110
  v_mfma_f32_16x16x32_bf16 v[88:91], a[136:139], a[120:123], v[88:91]
  v_cvt_pk_bf16_f32 v174, v26, v27
  v_exp_f32 v29, v111
  v_mfma_f32_16x16x32_bf16 v[88:91], a[140:143], a[124:127], v[88:91]
  v_exp_f32 v26, v112
  v_mfma_f32_16x16x32_bf16 v[68:71], a[144:147], a[64:67], v[128:131]
  v_cvt_pk_bf16_f32 v175, v28, v29
  v_exp_f32 v27, v113
  v_mfma_f32_16x16x32_bf16 v[68:71], a[148:151], a[68:71], v[68:71]
  v_exp_f32 v28, v114
  v_mfma_f32_16x16x32_bf16 v[68:71], a[152:155], a[72:75], v[68:71]
  v_cvt_pk_bf16_f32 v180, v26, v27
  v_exp_f32 v29, v115
  v_mfma_f32_16x16x32_bf16 v[68:71], a[156:159], a[76:79], v[68:71]
  v_exp_f32 v26, v116
  v_mfma_f32_16x16x32_bf16 v[76:79], a[144:147], a[80:83], v[132:135]
  v_cvt_pk_bf16_f32 v181, v28, v29
  v_exp_f32 v27, v117
  v_mfma_f32_16x16x32_bf16 v[76:79], a[148:151], a[84:87], v[76:79]
  v_exp_f32 v28, v118
  v_mfma_f32_16x16x32_bf16 v[76:79], a[152:155], a[88:91], v[76:79]
  v_cvt_pk_bf16_f32 v182, v26, v27
  v_exp_f32 v29, v119
  v_mfma_f32_16x16x32_bf16 v[76:79], a[156:159], a[92:95], v[76:79]
  v_exp_f32 v26, v120
  v_mfma_f32_16x16x32_bf16 v[84:87], a[144:147], a[96:99], v[136:139]
  v_cvt_pk_bf16_f32 v183, v28, v29
  v_exp_f32 v27, v121
  v_mfma_f32_16x16x32_bf16 v[84:87], a[148:151], a[100:103], v[84:87]
  v_exp_f32 v28, v122
  v_mfma_f32_16x16x32_bf16 v[84:87], a[152:155], a[104:107], v[84:87]
  v_cvt_pk_bf16_f32 v188, v26, v27
  v_exp_f32 v29, v123
  v_mfma_f32_16x16x32_bf16 v[84:87], a[156:159], a[108:111], v[84:87]
  v_exp_f32 v26, v124
  v_mfma_f32_16x16x32_bf16 v[92:95], a[144:147], a[112:115], v[140:143]
  v_cvt_pk_bf16_f32 v189, v28, v29
  v_exp_f32 v27, v125
  v_mfma_f32_16x16x32_bf16 v[92:95], a[148:151], a[116:119], v[92:95]
  v_exp_f32 v28, v126
  v_mfma_f32_16x16x32_bf16 v[92:95], a[152:155], a[120:123], v[92:95]
  v_cvt_pk_bf16_f32 v190, v26, v27
  v_exp_f32 v29, v127
  v_mfma_f32_16x16x32_bf16 v[92:95], a[156:159], a[124:127], v[92:95]
  s_nop 0
  s_waitcnt vmcnt(8)
  s_barrier
  ds_read_b128 a[128:131], v8 offset:24576
  ds_read_b128 a[132:135], v9 offset:24576
  ds_read_b128 a[136:139], v10 offset:24576
  ds_read_b128 a[140:143], v11 offset:24576
  ds_read_b128 a[144:147], v8 offset:28672
  ds_read_b128 a[148:151], v9 offset:28672
  s_add_u32 m0, s32, 49152
  ds_read_b128 a[152:155], v10 offset:28672
  s_add_u32 s46, s46, 8192
  ds_read_b128 a[156:159], v11 offset:28672
  v_cvt_pk_bf16_f32 v191, v28, v29
  buffer_load_dwordx4 v6, s[20:23], s46 offen offset:0 nt lds
  buffer_load_dwordx4 v7, s[20:23], s46 offen offset:1024 nt lds
  s_add_u32 m0, s32, 57344
  s_add_u32 s46, s46, 8192
  buffer_load_dwordx4 v6, s[20:23], s46 offen offset:0 nt lds
  buffer_load_dwordx4 v7, s[20:23], s46 offen offset:1024 nt lds
  s_waitcnt lgkmcnt(0)
  v_mfma_f32_16x16x32_bf16 v[96:99], a[128:131], a[64:67], v[128:131]
  v_mfma_f32_16x16x32_bf16 v[96:99], a[132:135], a[68:71], v[96:99]
  v_exp_f32 v26, v64
  v_mfma_f32_16x16x32_bf16 v[96:99], a[136:139], a[72:75], v[96:99]
  v_mfma_f32_16x16x32_bf16 v[96:99], a[140:143], a[76:79], v[96:99]
  v_exp_f32 v27, v65
  v_mfma_f32_16x16x32_bf16 v[104:107], a[128:131], a[80:83], v[132:135]
  v_cvt_pk_bf16_f32 v48, v26, v27
  v_mfma_f32_16x16x32_bf16 v[104:107], a[132:135], a[84:87], v[104:107]
  v_exp_f32 v28, v66
  v_mfma_f32_16x16x32_bf16 v[104:107], a[136:139], a[88:91], v[104:107]
  v_mfma_f32_16x16x32_bf16 v[104:107], a[140:143], a[92:95], v[104:107]
  v_exp_f32 v29, v67
  v_mfma_f32_16x16x32_bf16 v[112:115], a[128:131], a[96:99], v[136:139]
  v_cvt_pk_bf16_f32 v49, v28, v29
  v_mfma_f32_16x16x32_bf16 v[112:115], a[132:135], a[100:103], v[112:115]
  v_exp_f32 v26, v68
  v_mfma_f32_16x16x32_bf16 v[112:115], a[136:139], a[104:107], v[112:115]
  v_mfma_f32_16x16x32_bf16 v[112:115], a[140:143], a[108:111], v[112:115]
  v_exp_f32 v27, v69
  v_mfma_f32_16x16x32_bf16 v[120:123], a[128:131], a[112:115], v[140:143]
  v_cvt_pk_bf16_f32 v50, v26, v27
  v_mfma_f32_16x16x32_bf16 v[120:123], a[132:135], a[116:119], v[120:123]
  v_exp_f32 v28, v70
  v_mfma_f32_16x16x32_bf16 v[120:123], a[136:139], a[120:123], v[120:123]
  v_mfma_f32_16x16x32_bf16 v[120:123], a[140:143], a[124:127], v[120:123]
  v_exp_f32 v29, v71
  v_mfma_f32_16x16x32_bf16 v[100:103], a[144:147], a[64:67], v[128:131]
  v_cvt_pk_bf16_f32 v51, v28, v29
  v_mfma_f32_16x16x32_bf16 v[100:103], a[148:151], a[68:71], v[100:103]
  v_exp_f32 v26, v72
  v_mfma_f32_16x16x32_bf16 v[100:103], a[152:155], a[72:75], v[100:103]
  v_mfma_f32_16x16x32_bf16 v[100:103], a[156:159], a[76:79], v[100:103]
  v_exp_f32 v27, v73
  v_mfma_f32_16x16x32_bf16 v[108:111], a[144:147], a[80:83], v[132:135]
  v_cvt_pk_bf16_f32 v56, v26, v27
  v_mfma_f32_16x16x32_bf16 v[108:111], a[148:151], a[84:87], v[108:111]
  v_exp_f32 v28, v74
  v_mfma_f32_16x16x32_bf16 v[108:111], a[152:155], a[88:91], v[108:111]
  v_mfma_f32_16x16x32_bf16 v[108:111], a[156:159], a[92:95], v[108:111]
  v_exp_f32 v29, v75
  v_mfma_f32_16x16x32_bf16 v[116:119], a[144:147], a[96:99], v[136:139]
  v_cvt_pk_bf16_f32 v57, v28, v29
  v_mfma_f32_16x16x32_bf16 v[116:119], a[148:151], a[100:103], v[116:119]
  v_exp_f32 v26, v76
  v_mfma_f32_16x16x32_bf16 v[116:119], a[152:155], a[104:107], v[116:119]
  v_mfma_f32_16x16x32_bf16 v[116:119], a[156:159], a[108:111], v[116:119]
  v_exp_f32 v27, v77
  v_mfma_f32_16x16x32_bf16 v[124:127], a[144:147], a[112:115], v[140:143]
  v_cvt_pk_bf16_f32 v58, v26, v27
  v_mfma_f32_16x16x32_bf16 v[124:127], a[148:151], a[116:119], v[124:127]
  v_exp_f32 v28, v78
  v_mfma_f32_16x16x32_bf16 v[124:127], a[152:155], a[120:123], v[124:127]
  v_mfma_f32_16x16x32_bf16 v[124:127], a[156:159], a[124:127], v[124:127]
  v_exp_f32 v29, v79
  v_smfmac_f32_16x16x64_bf16 v[32:35], a[236:239], v[160:167], v1
  s_waitcnt vmcnt(10)
  s_barrier
  v_smfmac_f32_16x16x64_bf16 v[36:39], a[236:239], v[168:175], v1
  v_cvt_pk_bf16_f32 v59, v28, v29
  ds_read_b64_tr_b16 a[160:161], v12 offset:0
  ds_read_b64_tr_b16 a[162:163], v12 offset:4096
  ds_read_b64_tr_b16 a[164:165], v12 offset:8192
  ds_read_b64_tr_b16 a[166:167], v12 offset:12288
  ds_read_b64_tr_b16 a[168:169], v13 offset:0
  ds_read_b64_tr_b16 a[170:171], v13 offset:4096
  ds_read_b64_tr_b16 a[172:173], v13 offset:8192
  ds_read_b64_tr_b16 a[174:175], v13 offset:12288
  s_waitcnt lgkmcnt(0)
  v_mfma_f32_16x16x32_bf16 a[0:3], a[160:163], v[160:163], 0
  v_mfma_f32_16x16x32_bf16 a[0:3], a[164:167], v[164:167], a[0:3]
  v_exp_f32 v26, v80
  ds_read_b128 a[128:131], v8 offset:32768
  v_mfma_f32_16x16x32_bf16 a[32:35], a[160:163], v[168:171], 0
  v_mfma_f32_16x16x32_bf16 a[32:35], a[164:167], v[172:175], a[32:35]
  v_exp_f32 v27, v81
  ds_read_b128 a[132:135], v9 offset:32768
  v_mfma_f32_16x16x32_bf16 v[192:195], a[160:163], v[176:179], 0
  v_cvt_pk_bf16_f32 v144, v26, v27
  v_mfma_f32_16x16x32_bf16 v[192:195], a[164:167], v[180:183], v[192:195]
  v_exp_f32 v28, v82
  ds_read_b128 a[136:139], v10 offset:32768
  v_mfma_f32_16x16x32_bf16 v[224:227], a[160:163], v[184:187], 0
  v_mfma_f32_16x16x32_bf16 v[224:227], a[164:167], v[188:191], v[224:227]
  v_exp_f32 v29, v83
  ds_read_b128 a[140:143], v11 offset:32768
  v_mfma_f32_16x16x32_bf16 a[4:7], a[168:171], v[160:163], 0
  v_cvt_pk_bf16_f32 v145, v28, v29
  v_mfma_f32_16x16x32_bf16 a[4:7], a[172:175], v[164:167], a[4:7]
  v_exp_f32 v26, v84
  ds_read_b128 a[144:147], v8 offset:36864
  v_mfma_f32_16x16x32_bf16 a[36:39], a[168:171], v[168:171], 0
  v_mfma_f32_16x16x32_bf16 a[36:39], a[172:175], v[172:175], a[36:39]
  s_add_u32 m0, s32, 98304
  v_exp_f32 v27, v85
  ds_read_b128 a[148:151], v9 offset:36864
  v_mfma_f32_16x16x32_bf16 v[196:199], a[168:171], v[176:179], 0
  v_cvt_pk_bf16_f32 v146, v26, v27
  v_mfma_f32_16x16x32_bf16 v[196:199], a[172:175], v[180:183], v[196:199]
  s_add_u32 s33, s33, 8192
  v_exp_f32 v28, v86
  ds_read_b128 a[152:155], v10 offset:36864
  v_mfma_f32_16x16x32_bf16 v[228:231], a[168:171], v[184:187], 0
  v_mfma_f32_16x16x32_bf16 v[228:231], a[172:175], v[188:191], v[228:231]
  v_exp_f32 v29, v87
  ds_read_b64_tr_b16 a[176:177], v14 offset:0
  ds_read_b64_tr_b16 a[178:179], v14 offset:4096
  ds_read_b64_tr_b16 a[180:181], v14 offset:8192
  ds_read_b64_tr_b16 a[182:183], v14 offset:12288
  ds_read_b64_tr_b16 a[184:185], v15 offset:0
  ds_read_b64_tr_b16 a[186:187], v15 offset:4096
  ds_read_b64_tr_b16 a[188:189], v15 offset:8192
  ds_read_b64_tr_b16 a[190:191], v15 offset:12288
  s_waitcnt lgkmcnt(0)
  ds_read_b128 a[156:159], v11 offset:36864
  v_mfma_f32_16x16x32_bf16 a[8:11], a[176:179], v[160:163], 0
  v_cvt_pk_bf16_f32 v147, v28, v29
  v_mfma_f32_16x16x32_bf16 a[8:11], a[180:183], v[164:167], a[8:11]
  v_exp_f32 v26, v88
  v_mfma_f32_16x16x32_bf16 a[40:43], a[176:179], v[168:171], 0
  buffer_load_dwordx4 v24, s[24:27], s33 offen offset:0 nt lds
  v_mfma_f32_16x16x32_bf16 a[40:43], a[180:183], v[172:175], a[40:43]
  v_exp_f32 v27, v89
  v_mfma_f32_16x16x32_bf16 v[200:203], a[176:179], v[176:179], 0
  v_cvt_pk_bf16_f32 v152, v26, v27
  v_mfma_f32_16x16x32_bf16 v[200:203], a[180:183], v[180:183], v[200:203]
  v_exp_f32 v28, v90
  v_mfma_f32_16x16x32_bf16 v[232:235], a[176:179], v[184:187], 0
  buffer_load_dwordx4 v25, s[24:27], s33 offen offset:1024 nt lds
  v_mfma_f32_16x16x32_bf16 v[232:235], a[180:183], v[188:191], v[232:235]
  s_add_u32 m0, s32, 106496
  v_exp_f32 v29, v91
  v_mfma_f32_16x16x32_bf16 a[12:15], a[184:187], v[160:163], 0
  v_cvt_pk_bf16_f32 v153, v28, v29
  v_mfma_f32_16x16x32_bf16 a[12:15], a[188:191], v[164:167], a[12:15]
  s_add_u32 s33, s33, 8192
  v_exp_f32 v26, v92
  v_mfma_f32_16x16x32_bf16 a[44:47], a[184:187], v[168:171], 0
  buffer_load_dwordx4 v24, s[24:27], s33 offen offset:0 nt lds
  v_mfma_f32_16x16x32_bf16 a[44:47], a[188:191], v[172:175], a[44:47]
  v_exp_f32 v27, v93
  v_mfma_f32_16x16x32_bf16 v[204:207], a[184:187], v[176:179], 0
  v_cvt_pk_bf16_f32 v154, v26, v27
  v_mfma_f32_16x16x32_bf16 v[204:207], a[188:191], v[180:183], v[204:207]
  v_exp_f32 v28, v94
  v_mfma_f32_16x16x32_bf16 v[236:239], a[184:187], v[184:187], 0
  buffer_load_dwordx4 v25, s[24:27], s33 offen offset:1024 nt lds
  v_mfma_f32_16x16x32_bf16 v[236:239], a[188:191], v[188:191], v[236:239]
  s_waitcnt lgkmcnt(0)
  v_exp_f32 v29, v95
  v_mfma_f32_16x16x32_bf16 v[64:67], a[128:131], a[64:67], v[128:131]
  v_cvt_pk_bf16_f32 v155, v28, v29
  v_mfma_f32_16x16x32_bf16 v[64:67], a[132:135], a[68:71], v[64:67]
  v_exp_f32 v26, v96
  v_mfma_f32_16x16x32_bf16 v[64:67], a[136:139], a[72:75], v[64:67]
  v_mfma_f32_16x16x32_bf16 v[64:67], a[140:143], a[76:79], v[64:67]
  v_exp_f32 v27, v97
  v_mfma_f32_16x16x32_bf16 v[72:75], a[128:131], a[80:83], v[132:135]
  v_cvt_pk_bf16_f32 v52, v26, v27
  v_mfma_f32_16x16x32_bf16 v[72:75], a[132:135], a[84:87], v[72:75]
  v_exp_f32 v28, v98
  v_mfma_f32_16x16x32_bf16 v[72:75], a[136:139], a[88:91], v[72:75]
  v_mfma_f32_16x16x32_bf16 v[72:75], a[140:143], a[92:95], v[72:75]
  v_exp_f32 v29, v99
  v_mfma_f32_16x16x32_bf16 v[80:83], a[128:131], a[96:99], v[136:139]
  v_cvt_pk_bf16_f32 v53, v28, v29
  v_mfma_f32_16x16x32_bf16 v[80:83], a[132:135], a[100:103], v[80:83]
  v_exp_f32 v26, v100
  v_mfma_f32_16x16x32_bf16 v[80:83], a[136:139], a[104:107], v[80:83]
  v_mfma_f32_16x16x32_bf16 v[80:83], a[140:143], a[108:111], v[80:83]
  v_exp_f32 v27, v101
  v_mfma_f32_16x16x32_bf16 v[88:91], a[128:131], a[112:115], v[140:143]
  v_cvt_pk_bf16_f32 v54, v26, v27
  v_mfma_f32_16x16x32_bf16 v[88:91], a[132:135], a[116:119], v[88:91]
  v_exp_f32 v28, v102
  v_mfma_f32_16x16x32_bf16 v[88:91], a[136:139], a[120:123], v[88:91]
  v_mfma_f32_16x16x32_bf16 v[88:91], a[140:143], a[124:127], v[88:91]
  v_exp_f32 v29, v103
  v_mfma_f32_16x16x32_bf16 v[68:71], a[144:147], a[64:67], v[128:131]
  v_cvt_pk_bf16_f32 v55, v28, v29
  v_mfma_f32_16x16x32_bf16 v[68:71], a[148:151], a[68:71], v[68:71]
  v_exp_f32 v26, v104
  v_mfma_f32_16x16x32_bf16 v[68:71], a[152:155], a[72:75], v[68:71]
  v_mfma_f32_16x16x32_bf16 v[68:71], a[156:159], a[76:79], v[68:71]
  v_exp_f32 v27, v105
  v_mfma_f32_16x16x32_bf16 v[76:79], a[144:147], a[80:83], v[132:135]
  v_cvt_pk_bf16_f32 v60, v26, v27
  v_mfma_f32_16x16x32_bf16 v[76:79], a[148:151], a[84:87], v[76:79]
  v_exp_f32 v28, v106
  v_mfma_f32_16x16x32_bf16 v[76:79], a[152:155], a[88:91], v[76:79]
  v_mfma_f32_16x16x32_bf16 v[76:79], a[156:159], a[92:95], v[76:79]
  v_exp_f32 v29, v107
  v_mfma_f32_16x16x32_bf16 v[84:87], a[144:147], a[96:99], v[136:139]
  v_cvt_pk_bf16_f32 v61, v28, v29
  v_mfma_f32_16x16x32_bf16 v[84:87], a[148:151], a[100:103], v[84:87]
  v_exp_f32 v26, v108
  v_mfma_f32_16x16x32_bf16 v[84:87], a[152:155], a[104:107], v[84:87]
  v_mfma_f32_16x16x32_bf16 v[84:87], a[156:159], a[108:111], v[84:87]
  v_exp_f32 v27, v109
  v_mfma_f32_16x16x32_bf16 v[92:95], a[144:147], a[112:115], v[140:143]
  v_cvt_pk_bf16_f32 v62, v26, v27
  v_mfma_f32_16x16x32_bf16 v[92:95], a[148:151], a[116:119], v[92:95]
  v_exp_f32 v28, v110
  v_mfma_f32_16x16x32_bf16 v[92:95], a[152:155], a[120:123], v[92:95]
  v_mfma_f32_16x16x32_bf16 v[92:95], a[156:159], a[124:127], v[92:95]
  v_exp_f32 v29, v111
  v_smfmac_f32_16x16x64_bf16 v[40:43], a[236:239], v[176:183], v1
  s_waitcnt vmcnt(8)
  s_barrier
  v_smfmac_f32_16x16x64_bf16 v[44:47], a[236:239], v[184:191], v1
  v_cvt_pk_bf16_f32 v63, v28, v29
  ds_read_b64_tr_b16 a[160:161], v16 offset:0
  ds_read_b64_tr_b16 a[162:163], v16 offset:4096
  ds_read_b64_tr_b16 a[164:165], v16 offset:8192
  ds_read_b64_tr_b16 a[166:167], v16 offset:12288
  ds_read_b64_tr_b16 a[168:169], v17 offset:0
  ds_read_b64_tr_b16 a[170:171], v17 offset:4096
  ds_read_b64_tr_b16 a[172:173], v17 offset:8192
  ds_read_b64_tr_b16 a[174:175], v17 offset:12288
  s_waitcnt lgkmcnt(0)
  v_mfma_f32_16x16x32_bf16 a[16:19], a[160:163], v[160:163], 0
  v_mfma_f32_16x16x32_bf16 a[16:19], a[164:167], v[164:167], a[16:19]
  v_exp_f32 v26, v112
  ds_read_b128 a[128:131], v8 offset:40960
  v_mfma_f32_16x16x32_bf16 a[48:51], a[160:163], v[168:171], 0
  v_mfma_f32_16x16x32_bf16 a[48:51], a[164:167], v[172:175], a[48:51]
  v_exp_f32 v27, v113
  ds_read_b128 a[132:135], v9 offset:40960
  v_mfma_f32_16x16x32_bf16 v[208:211], a[160:163], v[176:179], 0
  v_cvt_pk_bf16_f32 v148, v26, v27
  v_mfma_f32_16x16x32_bf16 v[208:211], a[164:167], v[180:183], v[208:211]
  v_exp_f32 v28, v114
  ds_read_b128 a[136:139], v10 offset:40960
  v_mfma_f32_16x16x32_bf16 v[240:243], a[160:163], v[184:187], 0
  v_mfma_f32_16x16x32_bf16 v[240:243], a[164:167], v[188:191], v[240:243]
  v_exp_f32 v29, v115
  ds_read_b128 a[140:143], v11 offset:40960
  v_mfma_f32_16x16x32_bf16 a[20:23], a[168:171], v[160:163], 0
  v_cvt_pk_bf16_f32 v149, v28, v29
  v_mfma_f32_16x16x32_bf16 a[20:23], a[172:175], v[164:167], a[20:23]
  v_exp_f32 v26, v116
  ds_read_b128 a[144:147], v8 offset:45056
  v_mfma_f32_16x16x32_bf16 a[52:55], a[168:171], v[168:171], 0
  v_mfma_f32_16x16x32_bf16 a[52:55], a[172:175], v[172:175], a[52:55]
  s_add_u32 m0, s32, 114688
  v_exp_f32 v27, v117
  ds_read_b128 a[148:151], v9 offset:45056
  v_mfma_f32_16x16x32_bf16 v[212:215], a[168:171], v[176:179], 0
  v_cvt_pk_bf16_f32 v150, v26, v27
  v_mfma_f32_16x16x32_bf16 v[212:215], a[172:175], v[180:183], v[212:215]
  s_add_u32 s33, s33, 8192
  v_exp_f32 v28, v118
  ds_read_b128 a[152:155], v10 offset:45056
  v_mfma_f32_16x16x32_bf16 v[244:247], a[168:171], v[184:187], 0
  v_mfma_f32_16x16x32_bf16 v[244:247], a[172:175], v[188:191], v[244:247]
  v_exp_f32 v29, v119
  ds_read_b64_tr_b16 a[176:177], v18 offset:0
  ds_read_b64_tr_b16 a[178:179], v18 offset:4096
  ds_read_b64_tr_b16 a[180:181], v18 offset:8192
  ds_read_b64_tr_b16 a[182:183], v18 offset:12288
  ds_read_b64_tr_b16 a[184:185], v19 offset:0
  ds_read_b64_tr_b16 a[186:187], v19 offset:4096
  ds_read_b64_tr_b16 a[188:189], v19 offset:8192
  ds_read_b64_tr_b16 a[190:191], v19 offset:12288
  s_waitcnt lgkmcnt(0)
  ds_read_b128 a[156:159], v11 offset:45056
  v_mfma_f32_16x16x32_bf16 a[24:27], a[176:179], v[160:163], 0
  v_cvt_pk_bf16_f32 v151, v28, v29
  v_mfma_f32_16x16x32_bf16 a[24:27], a[180:183], v[164:167], a[24:27]
  v_exp_f32 v26, v120
  v_mfma_f32_16x16x32_bf16 a[56:59], a[176:179], v[168:171], 0
  buffer_load_dwordx4 v24, s[24:27], s33 offen offset:0 nt lds
  v_mfma_f32_16x16x32_bf16 a[56:59], a[180:183], v[172:175], a[56:59]
  v_exp_f32 v27, v121
  v_mfma_f32_16x16x32_bf16 v[216:219], a[176:179], v[176:179], 0
  v_cvt_pk_bf16_f32 v156, v26, v27
  v_mfma_f32_16x16x32_bf16 v[216:219], a[180:183], v[180:183], v[216:219]
  v_exp_f32 v28, v122
  v_mfma_f32_16x16x32_bf16 v[248:251], a[176:179], v[184:187], 0
  buffer_load_dwordx4 v25, s[24:27], s33 offen offset:1024 nt lds
  v_mfma_f32_16x16x32_bf16 v[248:251], a[180:183], v[188:191], v[248:251]
  s_add_u32 m0, s32, 122880
  v_exp_f32 v29, v123
  v_mfma_f32_16x16x32_bf16 a[28:31], a[184:187], v[160:163], 0
  v_cvt_pk_bf16_f32 v157, v28, v29
  v_mfma_f32_16x16x32_bf16 a[28:31], a[188:191], v[164:167], a[28:31]
  s_add_u32 s33, s33, 8192
  v_exp_f32 v26, v124
  v_mfma_f32_16x16x32_bf16 a[60:63], a[184:187], v[168:171], 0
  buffer_load_dwordx4 v24, s[24:27], s33 offen offset:0 nt lds
  v_mfma_f32_16x16x32_bf16 a[60:63], a[188:191], v[172:175], a[60:63]
  v_exp_f32 v27, v125
  v_mfma_f32_16x16x32_bf16 v[220:223], a[184:187], v[176:179], 0
  v_cvt_pk_bf16_f32 v158, v26, v27
  v_mfma_f32_16x16x32_bf16 v[220:223], a[188:191], v[180:183], v[220:223]
  v_exp_f32 v28, v126
  v_mfma_f32_16x16x32_bf16 v[252:255], a[184:187], v[184:187], 0
  buffer_load_dwordx4 v25, s[24:27], s33 offen offset:1024 nt lds
  v_mfma_f32_16x16x32_bf16 v[252:255], a[188:191], v[188:191], v[252:255]
  s_waitcnt lgkmcnt(0)
  v_exp_f32 v29, v127
  v_mfma_f32_16x16x32_bf16 v[96:99], a[128:131], a[64:67], v[128:131]
  v_cvt_pk_bf16_f32 v159, v28, v29
  v_mfma_f32_16x16x32_bf16 v[96:99], a[132:135], a[68:71], v[96:99]
  v_exp_f32 v26, v64
  ds_read_b64_tr_b16 a[160:161], v12 offset:16384
  v_mfma_f32_16x16x32_bf16 v[96:99], a[136:139], a[72:75], v[96:99]
  v_mfma_f32_16x16x32_bf16 v[96:99], a[140:143], a[76:79], v[96:99]
  v_exp_f32 v27, v65
  ds_read_b64_tr_b16 a[162:163], v12 offset:20480
  v_mfma_f32_16x16x32_bf16 v[104:107], a[128:131], a[80:83], v[132:135]
  v_cvt_pk_bf16_f32 v160, v26, v27
  v_mfma_f32_16x16x32_bf16 v[104:107], a[132:135], a[84:87], v[104:107]
  v_exp_f32 v28, v66
  ds_read_b64_tr_b16 a[164:165], v12 offset:24576
  v_mfma_f32_16x16x32_bf16 v[104:107], a[136:139], a[88:91], v[104:107]
  v_mfma_f32_16x16x32_bf16 v[104:107], a[140:143], a[92:95], v[104:107]
  v_exp_f32 v29, v67
  ds_read_b64_tr_b16 a[166:167], v12 offset:28672
  v_mfma_f32_16x16x32_bf16 v[112:115], a[128:131], a[96:99], v[136:139]
  v_cvt_pk_bf16_f32 v161, v28, v29
  v_mfma_f32_16x16x32_bf16 v[112:115], a[132:135], a[100:103], v[112:115]
  v_exp_f32 v26, v68
  ds_read_b64_tr_b16 a[168:169], v13 offset:16384
  v_mfma_f32_16x16x32_bf16 v[112:115], a[136:139], a[104:107], v[112:115]
  v_mfma_f32_16x16x32_bf16 v[112:115], a[140:143], a[108:111], v[112:115]
  v_exp_f32 v27, v69
  ds_read_b64_tr_b16 a[170:171], v13 offset:20480
  v_mfma_f32_16x16x32_bf16 v[120:123], a[128:131], a[112:115], v[140:143]
  v_cvt_pk_bf16_f32 v162, v26, v27
  v_mfma_f32_16x16x32_bf16 v[120:123], a[132:135], a[116:119], v[120:123]
  v_exp_f32 v28, v70
  ds_read_b64_tr_b16 a[172:173], v13 offset:24576
  v_mfma_f32_16x16x32_bf16 v[120:123], a[136:139], a[120:123], v[120:123]
  v_mfma_f32_16x16x32_bf16 v[120:123], a[140:143], a[124:127], v[120:123]
  v_exp_f32 v29, v71
  ds_read_b64_tr_b16 a[174:175], v13 offset:28672
  v_mfma_f32_16x16x32_bf16 v[100:103], a[144:147], a[64:67], v[128:131]
  v_cvt_pk_bf16_f32 v163, v28, v29
  v_mfma_f32_16x16x32_bf16 v[100:103], a[148:151], a[68:71], v[100:103]
  v_exp_f32 v26, v72
  ds_read_b64_tr_b16 a[176:177], v14 offset:16384
  v_mfma_f32_16x16x32_bf16 v[100:103], a[152:155], a[72:75], v[100:103]
  v_mfma_f32_16x16x32_bf16 v[100:103], a[156:159], a[76:79], v[100:103]
  v_exp_f32 v27, v73
  ds_read_b64_tr_b16 a[178:179], v14 offset:20480
  v_mfma_f32_16x16x32_bf16 v[108:111], a[144:147], a[80:83], v[132:135]
  v_cvt_pk_bf16_f32 v168, v26, v27
  v_mfma_f32_16x16x32_bf16 v[108:111], a[148:151], a[84:87], v[108:111]
  v_exp_f32 v28, v74
  ds_read_b64_tr_b16 a[180:181], v14 offset:24576
  v_mfma_f32_16x16x32_bf16 v[108:111], a[152:155], a[88:91], v[108:111]
  v_mfma_f32_16x16x32_bf16 v[108:111], a[156:159], a[92:95], v[108:111]
  v_exp_f32 v29, v75
  ds_read_b64_tr_b16 a[182:183], v14 offset:28672
  v_mfma_f32_16x16x32_bf16 v[116:119], a[144:147], a[96:99], v[136:139]
  v_cvt_pk_bf16_f32 v169, v28, v29
  v_mfma_f32_16x16x32_bf16 v[116:119], a[148:151], a[100:103], v[116:119]
  v_exp_f32 v26, v76
  ds_read_b64_tr_b16 a[184:185], v15 offset:16384
  v_mfma_f32_16x16x32_bf16 v[116:119], a[152:155], a[104:107], v[116:119]
  v_mfma_f32_16x16x32_bf16 v[116:119], a[156:159], a[108:111], v[116:119]
  v_exp_f32 v27, v77
  ds_read_b64_tr_b16 a[186:187], v15 offset:20480
  v_mfma_f32_16x16x32_bf16 v[124:127], a[144:147], a[112:115], v[140:143]
  v_cvt_pk_bf16_f32 v170, v26, v27
  v_mfma_f32_16x16x32_bf16 v[124:127], a[148:151], a[116:119], v[124:127]
  v_exp_f32 v28, v78
  ds_read_b64_tr_b16 a[188:189], v15 offset:24576
  v_mfma_f32_16x16x32_bf16 v[124:127], a[152:155], a[120:123], v[124:127]
  v_mfma_f32_16x16x32_bf16 v[124:127], a[156:159], a[124:127], v[124:127]
  v_exp_f32 v29, v79
  ds_read_b64_tr_b16 a[190:191], v15 offset:28672
  v_smfmac_f32_16x16x64_bf16 v[32:35], a[236:239], v[48:55], v1
  s_waitcnt vmcnt(10) lgkmcnt(8)
  s_barrier
  v_smfmac_f32_16x16x64_bf16 v[36:39], a[236:239], v[56:63], v1
  v_cvt_pk_bf16_f32 v171, v28, v29
  v_mfma_f32_16x16x32_bf16 a[0:3], a[160:163], v[48:51], a[0:3]
  v_mfma_f32_16x16x32_bf16 a[0:3], a[164:167], v[52:55], a[0:3]
  v_exp_f32 v26, v80
  ds_read_b128 a[128:131], v8 offset:49152
  v_mfma_f32_16x16x32_bf16 a[32:35], a[160:163], v[56:59], a[32:35]
  v_mfma_f32_16x16x32_bf16 a[32:35], a[164:167], v[60:63], a[32:35]
  s_mov_b32 m0, s32
  v_exp_f32 v27, v81
  ds_read_b128 a[132:135], v9 offset:49152
  v_mfma_f32_16x16x32_bf16 v[192:195], a[160:163], v[144:147], v[192:195]
  v_cvt_pk_bf16_f32 v176, v26, v27
  v_mfma_f32_16x16x32_bf16 v[192:195], a[164:167], v[148:151], v[192:195]
  s_add_u32 s46, s46, 8192
  v_exp_f32 v28, v82
  ds_read_b128 a[136:139], v10 offset:49152
  v_mfma_f32_16x16x32_bf16 v[224:227], a[160:163], v[152:155], v[224:227]
  buffer_load_dwordx4 v6, s[20:23], s46 offen offset:0 nt lds
  v_mfma_f32_16x16x32_bf16 v[224:227], a[164:167], v[156:159], v[224:227]
  v_exp_f32 v29, v83
  ds_read_b128 a[140:143], v11 offset:49152
  v_mfma_f32_16x16x32_bf16 a[4:7], a[168:171], v[48:51], a[4:7]
  v_cvt_pk_bf16_f32 v177, v28, v29
  v_mfma_f32_16x16x32_bf16 a[4:7], a[172:175], v[52:55], a[4:7]
  v_exp_f32 v26, v84
  ds_read_b128 a[144:147], v8 offset:53248
  v_mfma_f32_16x16x32_bf16 a[36:39], a[168:171], v[56:59], a[36:39]
  buffer_load_dwordx4 v7, s[20:23], s46 offen offset:1024 nt lds
  v_mfma_f32_16x16x32_bf16 a[36:39], a[172:175], v[60:63], a[36:39]
  s_add_u32 m0, s32, 8192
  v_exp_f32 v27, v85
  ds_read_b128 a[148:151], v9 offset:53248
  v_mfma_f32_16x16x32_bf16 v[196:199], a[168:171], v[144:147], v[196:199]
  v_cvt_pk_bf16_f32 v178, v26, v27
  v_mfma_f32_16x16x32_bf16 v[196:199], a[172:175], v[148:151], v[196:199]
  s_add_u32 s46, s46, 8192
  v_exp_f32 v28, v86
  ds_read_b128 a[152:155], v10 offset:53248
  v_mfma_f32_16x16x32_bf16 v[228:231], a[168:171], v[152:155], v[228:231]
  v_mfma_f32_16x16x32_bf16 v[228:231], a[172:175], v[156:159], v[228:231]
  s_waitcnt lgkmcnt(7)
  v_exp_f32 v29, v87
  ds_read_b128 a[156:159], v11 offset:53248
  v_mfma_f32_16x16x32_bf16 a[8:11], a[176:179], v[48:51], a[8:11]
  v_cvt_pk_bf16_f32 v179, v28, v29
  v_mfma_f32_16x16x32_bf16 a[8:11], a[180:183], v[52:55], a[8:11]
  v_exp_f32 v26, v88
  v_mfma_f32_16x16x32_bf16 a[40:43], a[176:179], v[56:59], a[40:43]
  buffer_load_dwordx4 v6, s[20:23], s46 offen offset:0 nt lds
  v_mfma_f32_16x16x32_bf16 a[40:43], a[180:183], v[60:63], a[40:43]
  v_exp_f32 v27, v89
  v_mfma_f32_16x16x32_bf16 v[200:203], a[176:179], v[144:147], v[200:203]
  v_cvt_pk_bf16_f32 v184, v26, v27
  v_mfma_f32_16x16x32_bf16 v[200:203], a[180:183], v[148:151], v[200:203]
  v_exp_f32 v28, v90
  v_mfma_f32_16x16x32_bf16 v[232:235], a[176:179], v[152:155], v[232:235]
  buffer_load_dwordx4 v7, s[20:23], s46 offen offset:1024 nt lds
  v_mfma_f32_16x16x32_bf16 v[232:235], a[180:183], v[156:159], v[232:235]
  s_add_u32 m0, s32, 65536
  v_exp_f32 v29, v91
  v_mfma_f32_16x16x32_bf16 a[12:15], a[184:187], v[48:51], a[12:15]
  v_cvt_pk_bf16_f32 v185, v28, v29
  v_mfma_f32_16x16x32_bf16 a[12:15], a[188:191], v[52:55], a[12:15]
  s_add_u32 s33, s33, 8192
  v_exp_f32 v26, v92
  v_mfma_f32_16x16x32_bf16 a[44:47], a[184:187], v[56:59], a[44:47]
  buffer_load_dwordx4 v24, s[24:27], s33 offen offset:0 nt lds
  v_mfma_f32_16x16x32_bf16 a[44:47], a[188:191], v[60:63], a[44:47]
  v_exp_f32 v27, v93
  v_mfma_f32_16x16x32_bf16 v[204:207], a[184:187], v[144:147], v[204:207]
  v_cvt_pk_bf16_f32 v186, v26, v27
  v_mfma_f32_16x16x32_bf16 v[204:207], a[188:191], v[148:151], v[204:207]
  v_exp_f32 v28, v94
  v_mfma_f32_16x16x32_bf16 v[236:239], a[184:187], v[152:155], v[236:239]
  buffer_load_dwordx4 v25, s[24:27], s33 offen offset:1024 nt lds
  v_mfma_f32_16x16x32_bf16 v[236:239], a[188:191], v[156:159], v[236:239]
  s_waitcnt lgkmcnt(0)
  v_exp_f32 v29, v95
  v_mfma_f32_16x16x32_bf16 v[64:67], a[128:131], a[64:67], v[128:131]
  v_cvt_pk_bf16_f32 v187, v28, v29
  v_mfma_f32_16x16x32_bf16 v[64:67], a[132:135], a[68:71], v[64:67]
  v_exp_f32 v26, v96
  ds_read_b64_tr_b16 a[160:161], v16 offset:16384
  v_mfma_f32_16x16x32_bf16 v[64:67], a[136:139], a[72:75], v[64:67]
L_isl2:
  s_cbranch_execz L_warm_done
  v_mfma_f32_16x16x32_bf16 v[64:67], a[140:143], a[76:79], v[64:67]
  v_exp_f32 v27, v97
  ds_read_b64_tr_b16 a[162:163], v16 offset:20480
  v_mfma_f32_16x16x32_bf16 v[72:75], a[128:131], a[80:83], v[132:135]
  v_cvt_pk_bf16_f32 v164, v26, v27
  v_mfma_f32_16x16x32_bf16 v[72:75], a[132:135], a[84:87], v[72:75]
  v_exp_f32 v28, v98
  ds_read_b64_tr_b16 a[164:165], v16 offset:24576
  v_mfma_f32_16x16x32_bf16 v[72:75], a[136:139], a[88:91], v[72:75]
  v_mfma_f32_16x16x32_bf16 v[72:75], a[140:143], a[92:95], v[72:75]
  v_exp_f32 v29, v99
  ds_read_b64_tr_b16 a[166:167], v16 offset:28672
  v_mfma_f32_16x16x32_bf16 v[80:83], a[128:131], a[96:99], v[136:139]
  v_cvt_pk_bf16_f32 v165, v28, v29
  v_mfma_f32_16x16x32_bf16 v[80:83], a[132:135], a[100:103], v[80:83]
  v_exp_f32 v26, v100
  ds_read_b64_tr_b16 a[168:169], v17 offset:16384
  v_mfma_f32_16x16x32_bf16 v[80:83], a[136:139], a[104:107], v[80:83]
  v_mfma_f32_16x16x32_bf16 v[80:83], a[140:143], a[108:111], v[80:83]
  v_exp_f32 v27, v101
  ds_read_b64_tr_b16 a[170:171], v17 offset:20480
  v_mfma_f32_16x16x32_bf16 v[88:91], a[128:131], a[112:115], v[140:143]
  v_cvt_pk_bf16_f32 v166, v26, v27
  v_mfma_f32_16x16x32_bf16 v[88:91], a[132:135], a[116:119], v[88:91]
  v_exp_f32 v28, v102
  ds_read_b64_tr_b16 a[172:173], v17 offset:24576
  v_mfma_f32_16x16x32_bf16 v[88:91], a[136:139], a[120:123], v[88:91]
  v_mfma_f32_16x16x32_bf16 v[88:91], a[140:143], a[124:127], v[88:91]
  v_exp_f32 v29, v103
  ds_read_b64_tr_b16 a[174:175], v17 offset:28672
  v_mfma_f32_16x16x32_bf16 v[68:71], a[144:147], a[64:67], v[128:131]
  v_cvt_pk_bf16_f32 v167, v28, v29
  v_mfma_f32_16x16x32_bf16 v[68:71], a[148:151], a[68:71], v[68:71]
  v_exp_f32 v26, v104
  ds_read_b64_tr_b16 a[176:177], v18 offset:16384
  v_mfma_f32_16x16x32_bf16 v[68:71], a[152:155], a[72:75], v[68:71]
  v_mfma_f32_16x16x32_bf16 v[68:71], a[156:159], a[76:79], v[68:71]
  v_exp_f32 v27, v105
  ds_read_b64_tr_b16 a[178:179], v18 offset:20480
  v_mfma_f32_16x16x32_bf16 v[76:79], a[144:147], a[80:83], v[132:135]
  v_cvt_pk_bf16_f32 v172, v26, v27
  v_mfma_f32_16x16x32_bf16 v[76:79], a[148:151], a[84:87], v[76:79]
  v_exp_f32 v28, v106
  ds_read_b64_tr_b16 a[180:181], v18 offset:24576
  v_mfma_f32_16x16x32_bf16 v[76:79], a[152:155], a[88:91], v[76:79]
  v_mfma_f32_16x16x32_bf16 v[76:79], a[156:159], a[92:95], v[76:79]
  v_exp_f32 v29, v107
  ds_read_b64_tr_b16 a[182:183], v18 offset:28672
  v_mfma_f32_16x16x32_bf16 v[84:87], a[144:147], a[96:99], v[136:139]
  v_cvt_pk_bf16_f32 v173, v28, v29
  v_mfma_f32_16x16x32_bf16 v[84:87], a[148:151], a[100:103], v[84:87]
  v_exp_f32 v26, v108
  ds_read_b64_tr_b16 a[184:185], v19 offset:16384
  v_mfma_f32_16x16x32_bf16 v[84:87], a[152:155], a[104:107], v[84:87]
  v_mfma_f32_16x16x32_bf16 v[84:87], a[156:159], a[108:111], v[84:87]
  v_exp_f32 v27, v109
  ds_read_b64_tr_b16 a[186:187], v19 offset:20480
  v_mfma_f32_16x16x32_bf16 v[92:95], a[144:147], a[112:115], v[140:143]
  v_cvt_pk_bf16_f32 v174, v26, v27
  v_mfma_f32_16x16x32_bf16 v[92:95], a[148:151], a[116:119], v[92:95]
  v_exp_f32 v28, v110
  ds_read_b64_tr_b16 a[188:189], v19 offset:24576
  v_mfma_f32_16x16x32_bf16 v[92:95], a[152:155], a[120:123], v[92:95]
  v_mfma_f32_16x16x32_bf16 v[92:95], a[156:159], a[124:127], v[92:95]
  v_exp_f32 v29, v111
  ds_read_b64_tr_b16 a[190:191], v19 offset:28672
  v_smfmac_f32_16x16x64_bf16 v[40:43], a[236:239], v[144:151], v1
  s_waitcnt vmcnt(10) lgkmcnt(8)
  s_barrier
  v_smfmac_f32_16x16x64_bf16 v[44:47], a[236:239], v[152:159], v1
  v_cvt_pk_bf16_f32 v175, v28, v29
  v_mfma_f32_16x16x32_bf16 a[16:19], a[160:163], v[48:51], a[16:19]
  v_mfma_f32_16x16x32_bf16 a[16:19], a[164:167], v[52:55], a[16:19]
  v_exp_f32 v26, v112
  ds_read_b128 a[128:131], v8 offset:57344
  v_mfma_f32_16x16x32_bf16 a[48:51], a[160:163], v[56:59], a[48:51]
  v_mfma_f32_16x16x32_bf16 a[48:51], a[164:167], v[60:63], a[48:51]
  s_add_u32 m0, s32, 73728
  v_exp_f32 v27, v113
  ds_read_b128 a[132:135], v9 offset:57344
  v_mfma_f32_16x16x32_bf16 v[208:211], a[160:163], v[144:147], v[208:211]
  v_cvt_pk_bf16_f32 v180, v26, v27
  v_mfma_f32_16x16x32_bf16 v[208:211], a[164:167], v[148:151], v[208:211]
  s_add_u32 s33, s33, 8192
  v_exp_f32 v28, v114
  ds_read_b128 a[136:139], v10 offset:57344
  v_mfma_f32_16x16x32_bf16 v[240:243], a[160:163], v[152:155], v[240:243]
  buffer_load_dwordx4 v24, s[24:27], s33 offen offset:0 nt lds
  v_mfma_f32_16x16x32_bf16 v[240:243], a[164:167], v[156:159], v[240:243]
  v_exp_f32 v29, v115
  ds_read_b128 a[140:143], v11 offset:57344
  v_mfma_f32_16x16x32_bf16 a[20:23], a[168:171], v[48:51], a[20:23]
  v_cvt_pk_bf16_f32 v181, v28, v29
  v_mfma_f32_16x16x32_bf16 a[20:23], a[172:175], v[52:55], a[20:23]
  v_exp_f32 v26, v116
  ds_read_b128 a[144:147], v8 offset:61440
  v_mfma_f32_16x16x32_bf16 a[52:55], a[168:171], v[56:59], a[52:55]
  buffer_load_dwordx4 v25, s[24:27], s33 offen offset:1024 nt lds
  v_mfma_f32_16x16x32_bf16 a[52:55], a[172:175], v[60:63], a[52:55]
  s_add_u32 m0, s32, 16384
  v_exp_f32 v27, v117
  ds_read_b128 a[148:151], v9 offset:61440
  v_mfma_f32_16x16x32_bf16 v[212:215], a[168:171], v[144:147], v[212:215]
  v_cvt_pk_bf16_f32 v182, v26, v27
  v_mfma_f32_16x16x32_bf16 v[212:215], a[172:175], v[148:151], v[212:215]
  s_add_u32 s46, s46, 8192
  v_exp_f32 v28, v118
  ds_read_b128 a[152:155], v10 offset:61440
  v_mfma_f32_16x16x32_bf16 v[244:247], a[168:171], v[152:155], v[244:247]
  v_mfma_f32_16x16x32_bf16 v[244:247], a[172:175], v[156:159], v[244:247]
  s_waitcnt lgkmcnt(7)
  v_exp_f32 v29, v119
  ds_read_b128 a[156:159], v11 offset:61440
  v_mfma_f32_16x16x32_bf16 a[24:27], a[176:179], v[48:51], a[24:27]
  v_cvt_pk_bf16_f32 v183, v28, v29
  v_mfma_f32_16x16x32_bf16 a[24:27], a[180:183], v[52:55], a[24:27]
  v_exp_f32 v26, v120
  v_mfma_f32_16x16x32_bf16 a[56:59], a[176:179], v[56:59], a[56:59]
  buffer_load_dwordx4 v6, s[20:23], s46 offen offset:0 nt lds
  v_mfma_f32_16x16x32_bf16 a[56:59], a[180:183], v[60:63], a[56:59]
  v_exp_f32 v27, v121
  v_mfma_f32_16x16x32_bf16 v[216:219], a[176:179], v[144:147], v[216:219]
  v_cvt_pk_bf16_f32 v188, v26, v27
  v_mfma_f32_16x16x32_bf16 v[216:219], a[180:183], v[148:151], v[216:219]
  v_exp_f32 v28, v122
  v_mfma_f32_16x16x32_bf16 v[248:251], a[176:179], v[152:155], v[248:251]
  buffer_load_dwordx4 v7, s[20:23], s46 offen offset:1024 nt lds
  v_mfma_f32_16x16x32_bf16 v[248:251], a[180:183], v[156:159], v[248:251]
  s_add_u32 m0, s32, 24576
  v_exp_f32 v29, v123
  v_mfma_f32_16x16x32_bf16 a[28:31], a[184:187], v[48:51], a[28:31]
  v_cvt_pk_bf16_f32 v189, v28, v29
  v_mfma_f32_16x16x32_bf16 a[28:31], a[188:191], v[52:55], a[28:31]
  s_add_u32 s46, s46, 8192
  v_exp_f32 v26, v124
  v_mfma_f32_16x16x32_bf16 a[60:63], a[184:187], v[56:59], a[60:63]
  buffer_load_dwordx4 v6, s[20:23], s46 offen offset:0 nt lds
  v_mfma_f32_16x16x32_bf16 a[60:63], a[188:191], v[60:63], a[60:63]
  v_exp_f32 v27, v125
  v_mfma_f32_16x16x32_bf16 v[220:223], a[184:187], v[144:147], v[220:223]
  v_cvt_pk_bf16_f32 v190, v26, v27
  v_mfma_f32_16x16x32_bf16 v[220:223], a[188:191], v[148:151], v[220:223]
  v_exp_f32 v28, v126
  v_mfma_f32_16x16x32_bf16 v[252:255], a[184:187], v[152:155], v[252:255]
  buffer_load_dwordx4 v7, s[20:23], s46 offen offset:1024 nt lds
  v_mfma_f32_16x16x32_bf16 v[252:255], a[188:191], v[156:159], v[252:255]
  s_waitcnt lgkmcnt(0)
  v_exp_f32 v29, v127
  v_mfma_f32_16x16x32_bf16 v[96:99], a[128:131], a[64:67], v[128:131]
  v_cvt_pk_bf16_f32 v191, v28, v29
  v_mfma_f32_16x16x32_bf16 v[96:99], a[132:135], a[68:71], v[96:99]
  v_exp_f32 v26, v64
  ds_read_b64_tr_b16 a[160:161], v12 offset:32768
  v_mfma_f32_16x16x32_bf16 v[96:99], a[136:139], a[72:75], v[96:99]
  v_mfma_f32_16x16x32_bf16 v[96:99], a[140:143], a[76:79], v[96:99]
  v_exp_f32 v27, v65
  ds_read_b64_tr_b16 a[162:163], v12 offset:36864
  v_mfma_f32_16x16x32_bf16 v[104:107], a[128:131], a[80:83], v[132:135]
  v_cvt_pk_bf16_f32 v48, v26, v27
  v_mfma_f32_16x16x32_bf16 v[104:107], a[132:135], a[84:87], v[104:107]
  v_exp_f32 v28, v66
  ds_read_b64_tr_b16 a[164:165], v12 offset:40960
  v_mfma_f32_16x16x32_bf16 v[104:107], a[136:139], a[88:91], v[104:107]
  v_mfma_f32_16x16x32_bf16 v[104:107], a[140:143], a[92:95], v[104:107]
  v_exp_f32 v29, v67
  ds_read_b64_tr_b16 a[166:167], v12 offset:45056
  v_mfma_f32_16x16x32_bf16 v[112:115], a[128:131], a[96:99], v[136:139]
  v_cvt_pk_bf16_f32 v49, v28, v29
  v_mfma_f32_16x16x32_bf16 v[112:115], a[132:135], a[100:103], v[112:115]
  v_exp_f32 v26, v68
  ds_read_b64_tr_b16 a[168:169], v13 offset:32768
  v_mfma_f32_16x16x32_bf16 v[112:115], a[136:139], a[104:107], v[112:115]
  v_mfma_f32_16x16x32_bf16 v[112:115], a[140:143], a[108:111], v[112:115]
  v_exp_f32 v27, v69
  ds_read_b64_tr_b16 a[170:171], v13 offset:36864
  v_mfma_f32_16x16x32_bf16 v[120:123], a[128:131], a[112:115], v[140:143]
  v_cvt_pk_bf16_f32 v50, v26, v27
  v_mfma_f32_16x16x32_bf16 v[120:123], a[132:135], a[116:119], v[120:123]
  v_exp_f32 v28, v70
  ds_read_b64_tr_b16 a[172:173], v13 offset:40960
  v_mfma_f32_16x16x32_bf16 v[120:123], a[136:139], a[120:123], v[120:123]
  v_mfma_f32_16x16x32_bf16 v[120:123], a[140:143], a[124:127], v[120:123]
  v_exp_f32 v29, v71
  ds_read_b64_tr_b16 a[174:175], v13 offset:45056
  v_mfma_f32_16x16x32_bf16 v[100:103], a[144:147], a[64:67], v[128:131]
  v_cvt_pk_bf16_f32 v51, v28, v29
  v_mfma_f32_16x16x32_bf16 v[100:103], a[148:151], a[68:71], v[100:103]
  v_exp_f32 v26, v72
  ds_read_b64_tr_b16 a[176:177], v14 offset:32768
  v_mfma_f32_16x16x32_bf16 v[100:103], a[152:155], a[72:75], v[100:103]
  v_mfma_f32_16x16x32_bf16 v[100:103], a[156:159], a[76:79], v[100:103]
  v_exp_f32 v27, v73
  ds_read_b64_tr_b16 a[178:179], v14 offset:36864
  v_mfma_f32_16x16x32_bf16 v[108:111], a[144:147], a[80:83], v[132:135]
  v_cvt_pk_bf16_f32 v56, v26, v27
  v_mfma_f32_16x16x32_bf16 v[108:111], a[148:151], a[84:87], v[108:111]
  v_exp_f32 v28, v74
  ds_read_b64_tr_b16 a[180:181], v14 offset:40960
  v_mfma_f32_16x16x32_bf16 v[108:111], a[152:155], a[88:91], v[108:111]
  v_mfma_f32_16x16x32_bf16 v[108:111], a[156:159], a[92:95], v[108:111]
  v_exp_f32 v29, v75
  ds_read_b64_tr_b16 a[182:183], v14 offset:45056
  v_mfma_f32_16x16x32_bf16 v[116:119], a[144:147], a[96:99], v[136:139]
  v_cvt_pk_bf16_f32 v57, v28, v29
  v_mfma_f32_16x16x32_bf16 v[116:119], a[148:151], a[100:103], v[116:119]
  v_exp_f32 v26, v76
  ds_read_b64_tr_b16 a[184:185], v15 offset:32768
  v_mfma_f32_16x16x32_bf16 v[116:119], a[152:155], a[104:107], v[116:119]
  v_mfma_f32_16x16x32_bf16 v[116:119], a[156:159], a[108:111], v[116:119]
  v_exp_f32 v27, v77
  ds_read_b64_tr_b16 a[186:187], v15 offset:36864
  v_mfma_f32_16x16x32_bf16 v[124:127], a[144:147], a[112:115], v[140:143]
  v_cvt_pk_bf16_f32 v58, v26, v27
  v_mfma_f32_16x16x32_bf16 v[124:127], a[148:151], a[116:119], v[124:127]
  v_exp_f32 v28, v78
  ds_read_b64_tr_b16 a[188:189], v15 offset:40960
  v_mfma_f32_16x16x32_bf16 v[124:127], a[152:155], a[120:123], v[124:127]
  v_mfma_f32_16x16x32_bf16 v[124:127], a[156:159], a[124:127], v[124:127]
  s_waitcnt vmcnt(8) lgkmcnt(7)
  v_exp_f32 v29, v79
  ds_read_b64_tr_b16 a[190:191], v15 offset:45056
  v_smfmac_f32_16x16x64_bf16 v[32:35], a[236:239], v[160:167], v1
  s_barrier
  v_smfmac_f32_16x16x64_bf16 v[36:39], a[236:239], v[168:175], v1
  v_cvt_pk_bf16_f32 v59, v28, v29
  v_mfma_f32_16x16x32_bf16 a[0:3], a[160:163], v[160:163], a[0:3]
  v_mfma_f32_16x16x32_bf16 a[0:3], a[164:167], v[164:167], a[0:3]
  v_exp_f32 v26, v80
  ds_read_b128 a[128:131], v8 offset:0
  v_mfma_f32_16x16x32_bf16 a[32:35], a[160:163], v[168:171], a[32:35]
  v_mfma_f32_16x16x32_bf16 a[32:35], a[164:167], v[172:175], a[32:35]
  v_exp_f32 v27, v81
  ds_read_b128 a[132:135], v9 offset:0
  v_mfma_f32_16x16x32_bf16 v[192:195], a[160:163], v[176:179], v[192:195]
  v_cvt_pk_bf16_f32 v144, v26, v27
  v_mfma_f32_16x16x32_bf16 v[192:195], a[164:167], v[180:183], v[192:195]
  v_exp_f32 v28, v82
  ds_read_b128 a[136:139], v10 offset:0
  v_mfma_f32_16x16x32_bf16 v[224:227], a[160:163], v[184:187], v[224:227]
  v_mfma_f32_16x16x32_bf16 v[224:227], a[164:167], v[188:191], v[224:227]
  v_exp_f32 v29, v83
  ds_read_b128 a[140:143], v11 offset:0
  v_mfma_f32_16x16x32_bf16 a[4:7], a[168:171], v[160:163], a[4:7]
  v_cvt_pk_bf16_f32 v145, v28, v29
  v_mfma_f32_16x16x32_bf16 a[4:7], a[172:175], v[164:167], a[4:7]
  v_exp_f32 v26, v84
  ds_read_b128 a[144:147], v8 offset:4096
  v_mfma_f32_16x16x32_bf16 a[36:39], a[168:171], v[168:171], a[36:39]
  v_mfma_f32_16x16x32_bf16 a[36:39], a[172:175], v[172:175], a[36:39]
  s_add_u32 m0, s32, 81920
  v_exp_f32 v27, v85
  ds_read_b128 a[148:151], v9 offset:4096
  v_mfma_f32_16x16x32_bf16 v[196:199], a[168:171], v[176:179], v[196:199]
  v_cvt_pk_bf16_f32 v146, v26, v27
  v_mfma_f32_16x16x32_bf16 v[196:199], a[172:175], v[180:183], v[196:199]
  s_add_u32 s33, s33, 8192
  v_exp_f32 v28, v86
  ds_read_b128 a[152:155], v10 offset:4096
  v_mfma_f32_16x16x32_bf16 v[228:231], a[168:171], v[184:187], v[228:231]
  v_mfma_f32_16x16x32_bf16 v[228:231], a[172:175], v[188:191], v[228:231]
  s_waitcnt lgkmcnt(7)
  v_exp_f32 v29, v87
  ds_read_b128 a[156:159], v11 offset:4096
  v_mfma_f32_16x16x32_bf16 a[8:11], a[176:179], v[160:163], a[8:11]
  v_cvt_pk_bf16_f32 v147, v28, v29
  v_mfma_f32_16x16x32_bf16 a[8:11], a[180:183], v[164:167], a[8:11]
  v_exp_f32 v26, v88
  v_mfma_f32_16x16x32_bf16 a[40:43], a[176:179], v[168:171], a[40:43]
  buffer_load_dwordx4 v24, s[24:27], s33 offen offset:0 nt lds
  v_mfma_f32_16x16x32_bf16 a[40:43], a[180:183], v[172:175], a[40:43]
  v_exp_f32 v27, v89
  v_mfma_f32_16x16x32_bf16 v[200:203], a[176:179], v[176:179], v[200:203]
  v_cvt_pk_bf16_f32 v152, v26, v27
  v_mfma_f32_16x16x32_bf16 v[200:203], a[180:183], v[180:183], v[200:203]
  v_exp_f32 v28, v90
  v_mfma_f32_16x16x32_bf16 v[232:235], a[176:179], v[184:187], v[232:235]
  buffer_load_dwordx4 v25, s[24:27], s33 offen offset:1024 nt lds
  v_mfma_f32_16x16x32_bf16 v[232:235], a[180:183], v[188:191], v[232:235]
  s_add_u32 m0, s32, 90112
  v_exp_f32 v29, v91
  v_mfma_f32_16x16x32_bf16 a[12:15], a[184:187], v[160:163], a[12:15]
  v_cvt_pk_bf16_f32 v153, v28, v29
  v_mfma_f32_16x16x32_bf16 a[12:15], a[188:191], v[164:167], a[12:15]
  s_add_u32 s33, s33, 8192
  v_exp_f32 v26, v92
  v_mfma_f32_16x16x32_bf16 a[44:47], a[184:187], v[168:171], a[44:47]
  buffer_load_dwordx4 v24, s[24:27], s33 offen offset:0 nt lds
  v_mfma_f32_16x16x32_bf16 a[44:47], a[188:191], v[172:175], a[44:47]
  v_exp_f32 v27, v93
  v_mfma_f32_16x16x32_bf16 v[204:207], a[184:187], v[176:179], v[204:207]
  v_cvt_pk_bf16_f32 v154, v26, v27
  v_mfma_f32_16x16x32_bf16 v[204:207], a[188:191], v[180:183], v[204:207]
  v_exp_f32 v28, v94
  v_mfma_f32_16x16x32_bf16 v[236:239], a[184:187], v[184:187], v[236:239]
  buffer_load_dwordx4 v25, s[24:27], s33 offen offset:1024 nt lds
  v_mfma_f32_16x16x32_bf16 v[236:239], a[188:191], v[188:191], v[236:239]
  s_waitcnt lgkmcnt(0)
  v_exp_f32 v29, v95
  v_mfma_f32_16x16x32_bf16 v[64:67], a[128:131], a[64:67], v[128:131]
  ds_read_b64_tr_b16 a[160:161], v16 offset:32768
  v_cvt_pk_bf16_f32 v155, v28, v29
  v_mfma_f32_16x16x32_bf16 v[64:67], a[132:135], a[68:71], v[64:67]
  v_exp_f32 v26, v96
  v_mfma_f32_16x16x32_bf16 v[64:67], a[136:139], a[72:75], v[64:67]
  ds_read_b64_tr_b16 a[162:163], v16 offset:36864
  v_xor_b32 v12, s53, v12
  v_mfma_f32_16x16x32_bf16 v[64:67], a[140:143], a[76:79], v[64:67]
  v_exp_f32 v27, v97
  v_mfma_f32_16x16x32_bf16 v[72:75], a[128:131], a[80:83], v[132:135]
  ds_read_b64_tr_b16 a[164:165], v16 offset:40960
  v_cvt_pk_bf16_f32 v52, v26, v27
  v_mfma_f32_16x16x32_bf16 v[72:75], a[132:135], a[84:87], v[72:75]
  v_exp_f32 v28, v98
  v_mfma_f32_16x16x32_bf16 v[72:75], a[136:139], a[88:91], v[72:75]
  ds_read_b64_tr_b16 a[166:167], v16 offset:45056
  v_xor_b32 v13, s53, v13
  v_mfma_f32_16x16x32_bf16 v[72:75], a[140:143], a[92:95], v[72:75]
  v_exp_f32 v29, v99
  v_mfma_f32_16x16x32_bf16 v[80:83], a[128:131], a[96:99], v[136:139]
  ds_read_b64_tr_b16 a[168:169], v17 offset:32768
  v_cvt_pk_bf16_f32 v53, v28, v29
  v_mfma_f32_16x16x32_bf16 v[80:83], a[132:135], a[100:103], v[80:83]
  v_exp_f32 v26, v100
  v_mfma_f32_16x16x32_bf16 v[80:83], a[136:139], a[104:107], v[80:83]
  ds_read_b64_tr_b16 a[170:171], v17 offset:36864
  v_xor_b32 v14, s53, v14
  v_mfma_f32_16x16x32_bf16 v[80:83], a[140:143], a[108:111], v[80:83]
  v_exp_f32 v27, v101
  v_mfma_f32_16x16x32_bf16 v[88:91], a[128:131], a[112:115], v[140:143]
  ds_read_b64_tr_b16 a[172:173], v17 offset:40960
  v_cvt_pk_bf16_f32 v54, v26, v27
  v_mfma_f32_16x16x32_bf16 v[88:91], a[132:135], a[116:119], v[88:91]
  v_exp_f32 v28, v102
  v_mfma_f32_16x16x32_bf16 v[88:91], a[136:139], a[120:123], v[88:91]
  ds_read_b64_tr_b16 a[174:175], v17 offset:45056
  v_xor_b32 v15, s53, v15
  v_mfma_f32_16x16x32_bf16 v[88:91], a[140:143], a[124:127], v[88:91]
  v_exp_f32 v29, v103
  v_mfma_f32_16x16x32_bf16 v[68:71], a[144:147], a[64:67], v[128:131]
  ds_read_b64_tr_b16 a[176:177], v18 offset:32768
  v_cvt_pk_bf16_f32 v55, v28, v29
  v_mfma_f32_16x16x32_bf16 v[68:71], a[148:151], a[68:71], v[68:71]
  v_exp_f32 v26, v104
  v_mfma_f32_16x16x32_bf16 v[68:71], a[152:155], a[72:75], v[68:71]
  ds_read_b64_tr_b16 a[178:179], v18 offset:36864
  v_mfma_f32_16x16x32_bf16 v[68:71], a[156:159], a[76:79], v[68:71]
  v_exp_f32 v27, v105
  v_mfma_f32_16x16x32_bf16 v[76:79], a[144:147], a[80:83], v[132:135]
  ds_read_b64_tr_b16 a[180:181], v18 offset:40960
  v_cvt_pk_bf16_f32 v60, v26, v27
  v_mfma_f32_16x16x32_bf16 v[76:79], a[148:151], a[84:87], v[76:79]
  v_exp_f32 v28, v106
  v_mfma_f32_16x16x32_bf16 v[76:79], a[152:155], a[88:91], v[76:79]
  ds_read_b64_tr_b16 a[182:183], v18 offset:45056
  v_mfma_f32_16x16x32_bf16 v[76:79], a[156:159], a[92:95], v[76:79]
  v_exp_f32 v29, v107
  v_mfma_f32_16x16x32_bf16 v[84:87], a[144:147], a[96:99], v[136:139]
  ds_read_b64_tr_b16 a[184:185], v19 offset:32768
  v_cvt_pk_bf16_f32 v61, v28, v29
  v_mfma_f32_16x16x32_bf16 v[84:87], a[148:151], a[100:103], v[84:87]
  v_exp_f32 v26, v108
  v_mfma_f32_16x16x32_bf16 v[84:87], a[152:155], a[104:107], v[84:87]
  ds_read_b64_tr_b16 a[186:187], v19 offset:36864
  v_mfma_f32_16x16x32_bf16 v[84:87], a[156:159], a[108:111], v[84:87]
  v_exp_f32 v27, v109
  v_mfma_f32_16x16x32_bf16 v[92:95], a[144:147], a[112:115], v[140:143]
  ds_read_b64_tr_b16 a[188:189], v19 offset:40960
  v_cvt_pk_bf16_f32 v62, v26, v27
  v_mfma_f32_16x16x32_bf16 v[92:95], a[148:151], a[116:119], v[92:95]
  v_exp_f32 v28, v110
  v_mfma_f32_16x16x32_bf16 v[92:95], a[152:155], a[120:123], v[92:95]
  ds_read_b64_tr_b16 a[190:191], v19 offset:45056
  v_mfma_f32_16x16x32_bf16 v[92:95], a[156:159], a[124:127], v[92:95]
  v_exp_f32 v29, v111
  v_smfmac_f32_16x16x64_bf16 v[40:43], a[236:239], v[176:183], v1
  s_waitcnt lgkmcnt(8)
  v_smfmac_f32_16x16x64_bf16 v[44:47], a[236:239], v[184:191], v1
  v_cvt_pk_bf16_f32 v63, v28, v29
  v_mfma_f32_16x16x32_bf16 a[16:19], a[160:163], v[160:163], a[16:19]
  ds_read_b128 a[128:131], v8 offset:8192
  v_mfma_f32_16x16x32_bf16 a[16:19], a[164:167], v[164:167], a[16:19]
  v_exp_f32 v26, v112
  v_mfma_f32_16x16x32_bf16 a[48:51], a[160:163], v[168:171], a[48:51]
  ds_read_b128 a[132:135], v9 offset:8192
  v_xor_b32 v16, s53, v16
  v_mfma_f32_16x16x32_bf16 a[48:51], a[164:167], v[172:175], a[48:51]
  v_exp_f32 v27, v113
  v_mfma_f32_16x16x32_bf16 v[208:211], a[160:163], v[176:179], v[208:211]
  ds_read_b128 a[136:139], v10 offset:8192
  v_cvt_pk_bf16_f32 v148, v26, v27
  v_mfma_f32_16x16x32_bf16 v[208:211], a[164:167], v[180:183], v[208:211]
  v_exp_f32 v28, v114
  v_mfma_f32_16x16x32_bf16 v[240:243], a[160:163], v[184:187], v[240:243]
  ds_read_b128 a[140:143], v11 offset:8192
  v_xor_b32 v17, s53, v17
  v_mfma_f32_16x16x32_bf16 v[240:243], a[164:167], v[188:191], v[240:243]
  v_exp_f32 v29, v115
  v_mfma_f32_16x16x32_bf16 a[20:23], a[168:171], v[160:163], a[20:23]
  ds_read_b128 a[144:147], v8 offset:12288
  v_cvt_pk_bf16_f32 v149, v28, v29
  v_mfma_f32_16x16x32_bf16 a[20:23], a[172:175], v[164:167], a[20:23]
  v_exp_f32 v26, v116
  v_mfma_f32_16x16x32_bf16 a[52:55], a[168:171], v[168:171], a[52:55]
  ds_read_b128 a[148:151], v9 offset:12288
  v_xor_b32 v18, s53, v18
  v_mfma_f32_16x16x32_bf16 a[52:55], a[172:175], v[172:175], a[52:55]
  s_add_u32 m0, s32, 32768
  v_exp_f32 v27, v117
  v_mfma_f32_16x16x32_bf16 v[212:215], a[168:171], v[176:179], v[212:215]
  ds_read_b128 a[152:155], v10 offset:12288
  v_cvt_pk_bf16_f32 v150, v26, v27
  v_mfma_f32_16x16x32_bf16 v[212:215], a[172:175], v[180:183], v[212:215]
  s_add_u32 s46, s46, 8192
  v_exp_f32 v28, v118
  v_mfma_f32_16x16x32_bf16 v[244:247], a[168:171], v[184:187], v[244:247]
  ds_read_b128 a[156:159], v11 offset:12288
  v_xor_b32 v19, s53, v19
  v_mfma_f32_16x16x32_bf16 v[244:247], a[172:175], v[188:191], v[244:247]
  s_waitcnt lgkmcnt(8)
  v_exp_f32 v29, v119
  v_mfma_f32_16x16x32_bf16 a[24:27], a[176:179], v[160:163], a[24:27]
  v_cvt_pk_bf16_f32 v151, v28, v29
  v_mfma_f32_16x16x32_bf16 a[24:27], a[180:183], v[164:167], a[24:27]
  v_exp_f32 v26, v120
  v_mfma_f32_16x16x32_bf16 a[56:59], a[176:179], v[168:171], a[56:59]
  buffer_load_dwordx4 v6, s[20:23], s46 offen offset:0 nt lds
  v_mfma_f32_16x16x32_bf16 a[56:59], a[180:183], v[172:175], a[56:59]
  v_exp_f32 v27, v121
  v_mfma_f32_16x16x32_bf16 v[216:219], a[176:179], v[176:179], v[216:219]
  v_cvt_pk_bf16_f32 v156, v26, v27
  v_mfma_f32_16x16x32_bf16 v[216:219], a[180:183], v[180:183], v[216:219]
  v_exp_f32 v28, v122
  v_mfma_f32_16x16x32_bf16 v[248:251], a[176:179], v[184:187], v[248:251]
  buffer_load_dwordx4 v7, s[20:23], s46 offen offset:1024 nt lds
  v_mfma_f32_16x16x32_bf16 v[248:251], a[180:183], v[188:191], v[248:251]
  s_add_u32 m0, s32, 40960
  v_exp_f32 v29, v123
  v_mfma_f32_16x16x32_bf16 a[28:31], a[184:187], v[160:163], a[28:31]
  v_cvt_pk_bf16_f32 v157, v28, v29
  v_mfma_f32_16x16x32_bf16 a[28:31], a[188:191], v[164:167], a[28:31]
  s_add_u32 s46, s46, 8192
  v_exp_f32 v26, v124
  v_mfma_f32_16x16x32_bf16 a[60:63], a[184:187], v[168:171], a[60:63]
  buffer_load_dwordx4 v6, s[20:23], s46 offen offset:0 nt lds
  v_mfma_f32_16x16x32_bf16 a[60:63], a[188:191], v[172:175], a[60:63]
  v_exp_f32 v27, v125
  v_mfma_f32_16x16x32_bf16 v[220:223], a[184:187], v[176:179], v[220:223]
  v_cvt_pk_bf16_f32 v158, v26, v27
  v_mfma_f32_16x16x32_bf16 v[220:223], a[188:191], v[180:183], v[220:223]
  v_exp_f32 v28, v126
  v_mfma_f32_16x16x32_bf16 v[252:255], a[184:187], v[184:187], v[252:255]
  buffer_load_dwordx4 v7, s[20:23], s46 offen offset:1024 nt lds
  v_mfma_f32_16x16x32_bf16 v[252:255], a[188:191], v[188:191], v[252:255]
  s_waitcnt lgkmcnt(0)
  v_exp_f32 v29, v127
  s_mov_b32 s60, 0
.p2align 6
L_loop:
  v_mfma_f32_16x16x32_bf16 v[96:99], a[128:131], a[64:67], v[128:131]
  ds_read_b64_tr_b16 a[160:161], v12 offset:16384
  v_cvt_pk_bf16_f32 v159, v28, v29
  v_mfma_f32_16x16x32_bf16 v[96:99], a[132:135], a[68:71], v[96:99]
  v_exp_f32 v26, v64
  v_mfma_f32_16x16x32_bf16 v[96:99], a[136:139], a[72:75], v[96:99]
  ds_read_b64_tr_b16 a[162:163], v12 offset:20480
  v_mfma_f32_16x16x32_bf16 v[96:99], a[140:143], a[76:79], v[96:99]
  v_exp_f32 v27, v65
  v_mfma_f32_16x16x32_bf16 v[104:107], a[128:131], a[80:83], v[132:135]
  ds_read_b64_tr_b16 a[164:165], v12 offset:24576
  v_cvt_pk_bf16_f32 v160, v26, v27
  v_mfma_f32_16x16x32_bf16 v[104:107], a[132:135], a[84:87], v[104:107]
  v_exp_f32 v28, v66
  v_mfma_f32_16x16x32_bf16 v[104:107], a[136:139], a[88:91], v[104:107]
  ds_read_b64_tr_b16 a[166:167], v12 offset:28672
  v_mfma_f32_16x16x32_bf16 v[104:107], a[140:143], a[92:95], v[104:107]
  v_exp_f32 v29, v67
  v_mfma_f32_16x16x32_bf16 v[112:115], a[128:131], a[96:99], v[136:139]
  ds_read_b64_tr_b16 a[168:169], v13 offset:16384
  v_cvt_pk_bf16_f32 v161, v28, v29
  v_mfma_f32_16x16x32_bf16 v[112:115], a[132:135], a[100:103], v[112:115]
  v_exp_f32 v26, v68
  v_mfma_f32_16x16x32_bf16 v[112:115], a[136:139], a[104:107], v[112:115]
  ds_read_b64_tr_b16 a[170:171], v13 offset:20480
  v_mfma_f32_16x16x32_bf16 v[112:115], a[140:143], a[108:111], v[112:115]
  v_exp_f32 v27, v69
  v_mfma_f32_16x16x32_bf16 v[120:123], a[128:131], a[112:115], v[140:143]
  ds_read_b64_tr_b16 a[172:173], v13 offset:24576
  v_cvt_pk_bf16_f32 v162, v26, v27
  v_mfma_f32_16x16x32_bf16 v[120:123], a[132:135], a[116:119], v[120:123]
  v_exp_f32 v28, v70
  v_mfma_f32_16x16x32_bf16 v[120:123], a[136:139], a[120:123], v[120:123]
  ds_read_b64_tr_b16 a[174:175], v13 offset:28672
  v_mfma_f32_16x16x32_bf16 v[120:123], a[140:143], a[124:127], v[120:123]
  v_exp_f32 v29, v71
  v_mfma_f32_16x16x32_bf16 v[100:103], a[144:147], a[64:67], v[128:131]
  ds_read_b64_tr_b16 a[176:177], v14 offset:16384
  v_cvt_pk_bf16_f32 v163, v28, v29
  v_mfma_f32_16x16x32_bf16 v[100:103], a[148:151], a[68:71], v[100:103]
  v_exp_f32 v26, v72
  v_mfma_f32_16x16x32_bf16 v[100:103], a[152:155], a[72:75], v[100:103]
  ds_read_b64_tr_b16 a[178:179], v14 offset:20480
  v_mfma_f32_16x16x32_bf16 v[100:103], a[156:159], a[76:79], v[100:103]
  v_exp_f32 v27, v73
  v_mfma_f32_16x16x32_bf16 v[108:111], a[144:147], a[80:83], v[132:135]
  ds_read_b64_tr_b16 a[180:181], v14 offset:24576
  v_cvt_pk_bf16_f32 v168, v26, v27
  v_mfma_f32_16x16x32_bf16 v[108:111], a[148:151], a[84:87], v[108:111]
  v_exp_f32 v28, v74
  v_mfma_f32_16x16x32_bf16 v[108:111], a[152:155], a[88:91], v[108:111]
  ds_read_b64_tr_b16 a[182:183], v14 offset:28672
  v_mfma_f32_16x16x32_bf16 v[108:111], a[156:159], a[92:95], v[108:111]
  v_exp_f32 v29, v75
  v_mfma_f32_16x16x32_bf16 v[116:119], a[144:147], a[96:99], v[136:139]
  ds_read_b64_tr_b16 a[184:185], v15 offset:16384
  v_cvt_pk_bf16_f32 v169, v28, v29
  v_mfma_f32_16x16x32_bf16 v[116:119], a[148:151], a[100:103], v[116:119]
  v_exp_f32 v26, v76
  v_mfma_f32_16x16x32_bf16 v[116:119], a[152:155], a[104:107], v[116:119]
  ds_read_b64_tr_b16 a[186:187], v15 offset:20480
  v_mfma_f32_16x16x32_bf16 v[116:119], a[156:159], a[108:111], v[116:119]
  v_exp_f32 v27, v77
  v_mfma_f32_16x16x32_bf16 v[124:127], a[144:147], a[112:115], v[140:143]
  ds_read_b64_tr_b16 a[188:189], v15 offset:24576
  v_cvt_pk_bf16_f32 v170, v26, v27
  v_mfma_f32_16x16x32_bf16 v[124:127], a[148:151], a[116:119], v[124:127]
  v_exp_f32 v28, v78
  v_mfma_f32_16x16x32_bf16 v[124:127], a[152:155], a[120:123], v[124:127]
  ds_read_b64_tr_b16 a[190:191], v15 offset:28672
  v_mfma_f32_16x16x32_bf16 v[124:127], a[156:159], a[124:127], v[124:127]
  s_waitcnt vmcnt(8) lgkmcnt(8)
  v_exp_f32 v29, v79
  v_smfmac_f32_16x16x64_bf16 v[32:35], a[236:239], v[48:55], v1
  s_barrier
  v_smfmac_f32_16x16x64_bf16 v[36:39], a[236:239], v[56:63], v1
  v_cvt_pk_bf16_f32 v171, v28, v29
  v_mfma_f32_16x16x32_bf16 a[0:3], a[160:163], v[48:51], a[0:3]
  ds_read_b128 a[128:131], v8 offset:16384
  v_mfma_f32_16x16x32_bf16 a[0:3], a[164:167], v[52:55], a[0:3]
  v_exp_f32 v26, v80
  v_mfma_f32_16x16x32_bf16 a[32:35], a[160:163], v[56:59], a[32:35]
  ds_read_b128 a[132:135], v9 offset:16384
  v_mfma_f32_16x16x32_bf16 a[32:35], a[164:167], v[60:63], a[32:35]
  v_exp_f32 v27, v81
  v_mfma_f32_16x16x32_bf16 v[192:195], a[160:163], v[144:147], v[192:195]
  ds_read_b128 a[136:139], v10 offset:16384
  v_cvt_pk_bf16_f32 v176, v26, v27
  v_mfma_f32_16x16x32_bf16 v[192:195], a[164:167], v[148:151], v[192:195]
  v_exp_f32 v28, v82
  v_mfma_f32_16x16x32_bf16 v[224:227], a[160:163], v[152:155], v[224:227]
  ds_read_b128 a[140:143], v11 offset:16384
  v_mfma_f32_16x16x32_bf16 v[224:227], a[164:167], v[156:159], v[224:227]
  v_exp_f32 v29, v83
  v_mfma_f32_16x16x32_bf16 a[4:7], a[168:171], v[48:51], a[4:7]
  ds_read_b128 a[144:147], v8 offset:20480
  v_cvt_pk_bf16_f32 v177, v28, v29
  v_mfma_f32_16x16x32_bf16 a[4:7], a[172:175], v[52:55], a[4:7]
  v_exp_f32 v26, v84
  v_mfma_f32_16x16x32_bf16 a[36:39], a[168:171], v[56:59], a[36:39]
  ds_read_b128 a[148:151], v9 offset:20480
  v_mfma_f32_16x16x32_bf16 a[36:39], a[172:175], v[60:63], a[36:39]
  s_mov_b32 m0, s55
  v_exp_f32 v27, v85
  v_mfma_f32_16x16x32_bf16 v[196:199], a[168:171], v[144:147], v[196:199]
  ds_read_b128 a[152:155], v10 offset:20480
  v_cvt_pk_bf16_f32 v178, v26, v27
  v_mfma_f32_16x16x32_bf16 v[196:199], a[172:175], v[148:151], v[196:199]
  s_add_u32 s33, s33, 8192
  v_exp_f32 v28, v86
  v_mfma_f32_16x16x32_bf16 v[228:231], a[168:171], v[152:155], v[228:231]
  ds_read_b128 a[156:159], v11 offset:20480
  v_mfma_f32_16x16x32_bf16 v[228:231], a[172:175], v[156:159], v[228:231]
  s_waitcnt lgkmcnt(8)
  v_exp_f32 v29, v87
  v_mfma_f32_16x16x32_bf16 a[8:11], a[176:179], v[48:51], a[8:11]
  v_cvt_pk_bf16_f32 v179, v28, v29
  v_mfma_f32_16x16x32_bf16 a[8:11], a[180:183], v[52:55], a[8:11]
  v_exp_f32 v26, v88
  v_mfma_f32_16x16x32_bf16 a[40:43], a[176:179], v[56:59], a[40:43]
  buffer_load_dwordx4 v24, s[24:27], s33 offen offset:0 nt lds
  v_mfma_f32_16x16x32_bf16 a[40:43], a[180:183], v[60:63], a[40:43]
  v_exp_f32 v27, v89
  v_mfma_f32_16x16x32_bf16 v[200:203], a[176:179], v[144:147], v[200:203]
  v_cvt_pk_bf16_f32 v184, v26, v27
  v_mfma_f32_16x16x32_bf16 v[200:203], a[180:183], v[148:151], v[200:203]
  v_exp_f32 v28, v90
  v_mfma_f32_16x16x32_bf16 v[232:235], a[176:179], v[152:155], v[232:235]
  buffer_load_dwordx4 v25, s[24:27], s33 offen offset:1024 nt lds
L_isl3:
  s_cbranch_execz L_warm_done
  v_mfma_f32_16x16x32_bf16 v[232:235], a[180:183], v[156:159], v[232:235]
  s_add_u32 m0, s55, 8192
  v_exp_f32 v29, v91
  v_mfma_f32_16x16x32_bf16 a[12:15], a[184:187], v[48:51], a[12:15]
  v_cvt_pk_bf16_f32 v185, v28, v29
  v_mfma_f32_16x16x32_bf16 a[12:15], a[188:191], v[52:55], a[12:15]
  s_add_u32 s33, s33, 8192
  v_exp_f32 v26, v92
  v_mfma_f32_16x16x32_bf16 a[44:47], a[184:187], v[56:59], a[44:47]
  buffer_load_dwordx4 v24, s[24:27], s33 offen offset:0 nt lds
  v_mfma_f32_16x16x32_bf16 a[44:47], a[188:191], v[60:63], a[44:47]
  v_exp_f32 v27, v93
  v_mfma_f32_16x16x32_bf16 v[204:207], a[184:187], v[144:147], v[204:207]
  v_cvt_pk_bf16_f32 v186, v26, v27
  v_mfma_f32_16x16x32_bf16 v[204:207], a[188:191], v[148:151], v[204:207]
  v_exp_f32 v28, v94
  v_mfma_f32_16x16x32_bf16 v[236:239], a[184:187], v[152:155], v[236:239]
  buffer_load_dwordx4 v25, s[24:27], s33 offen offset:1024 nt lds
  v_mfma_f32_16x16x32_bf16 v[236:239], a[188:191], v[156:159], v[236:239]
  s_waitcnt lgkmcnt(0)
  v_exp_f32 v29, v95
  v_mfma_f32_16x16x32_bf16 v[64:67], a[128:131], a[64:67], v[128:131]
  ds_read_b64_tr_b16 a[160:161], v16 offset:16384
  v_cvt_pk_bf16_f32 v187, v28, v29
  v_mfma_f32_16x16x32_bf16 v[64:67], a[132:135], a[68:71], v[64:67]
  v_exp_f32 v26, v96
  v_mfma_f32_16x16x32_bf16 v[64:67], a[136:139], a[72:75], v[64:67]
  ds_read_b64_tr_b16 a[162:163], v16 offset:20480
  v_xor_b32 v12, s53, v12
  v_mfma_f32_16x16x32_bf16 v[64:67], a[140:143], a[76:79], v[64:67]
  v_exp_f32 v27, v97
  v_mfma_f32_16x16x32_bf16 v[72:75], a[128:131], a[80:83], v[132:135]
  ds_read_b64_tr_b16 a[164:165], v16 offset:24576
  v_cvt_pk_bf16_f32 v164, v26, v27
  v_mfma_f32_16x16x32_bf16 v[72:75], a[132:135], a[84:87], v[72:75]
  v_exp_f32 v28, v98
  v_mfma_f32_16x16x32_bf16 v[72:75], a[136:139], a[88:91], v[72:75]
  ds_read_b64_tr_b16 a[166:167], v16 offset:28672
  v_xor_b32 v13, s53, v13
  v_mfma_f32_16x16x32_bf16 v[72:75], a[140:143], a[92:95], v[72:75]
  v_exp_f32 v29, v99
  v_mfma_f32_16x16x32_bf16 v[80:83], a[128:131], a[96:99], v[136:139]
  ds_read_b64_tr_b16 a[168:169], v17 offset:16384
  v_cvt_pk_bf16_f32 v165, v28, v29
  v_mfma_f32_16x16x32_bf16 v[80:83], a[132:135], a[100:103], v[80:83]
  v_exp_f32 v26, v100
  v_mfma_f32_16x16x32_bf16 v[80:83], a[136:139], a[104:107], v[80:83]
  ds_read_b64_tr_b16 a[170:171], v17 offset:20480
  v_xor_b32 v14, s53, v14
  v_mfma_f32_16x16x32_bf16 v[80:83], a[140:143], a[108:111], v[80:83]
  v_exp_f32 v27, v101
  v_mfma_f32_16x16x32_bf16 v[88:91], a[128:131], a[112:115], v[140:143]
  ds_read_b64_tr_b16 a[172:173], v17 offset:24576
  v_cvt_pk_bf16_f32 v166, v26, v27
  v_mfma_f32_16x16x32_bf16 v[88:91], a[132:135], a[116:119], v[88:91]
  v_exp_f32 v28, v102
  v_mfma_f32_16x16x32_bf16 v[88:91], a[136:139], a[120:123], v[88:91]
  ds_read_b64_tr_b16 a[174:175], v17 offset:28672
  v_xor_b32 v15, s53, v15
  v_mfma_f32_16x16x32_bf16 v[88:91], a[140:143], a[124:127], v[88:91]
  v_exp_f32 v29, v103
  v_mfma_f32_16x16x32_bf16 v[68:71], a[144:147], a[64:67], v[128:131]
  ds_read_b64_tr_b16 a[176:177], v18 offset:16384
  v_cvt_pk_bf16_f32 v167, v28, v29
  v_mfma_f32_16x16x32_bf16 v[68:71], a[148:151], a[68:71], v[68:71]
  v_exp_f32 v26, v104
  v_mfma_f32_16x16x32_bf16 v[68:71], a[152:155], a[72:75], v[68:71]
  ds_read_b64_tr_b16 a[178:179], v18 offset:20480
  v_mfma_f32_16x16x32_bf16 v[68:71], a[156:159], a[76:79], v[68:71]
  v_exp_f32 v27, v105
  v_mfma_f32_16x16x32_bf16 v[76:79], a[144:147], a[80:83], v[132:135]
  ds_read_b64_tr_b16 a[180:181], v18 offset:24576
  v_cvt_pk_bf16_f32 v172, v26, v27
  v_mfma_f32_16x16x32_bf16 v[76:79], a[148:151], a[84:87], v[76:79]
  v_exp_f32 v28, v106
  v_mfma_f32_16x16x32_bf16 v[76:79], a[152:155], a[88:91], v[76:79]
  ds_read_b64_tr_b16 a[182:183], v18 offset:28672
  v_mfma_f32_16x16x32_bf16 v[76:79], a[156:159], a[92:95], v[76:79]
  v_exp_f32 v29, v107
  v_mfma_f32_16x16x32_bf16 v[84:87], a[144:147], a[96:99], v[136:139]
  ds_read_b64_tr_b16 a[184:185], v19 offset:16384
  v_cvt_pk_bf16_f32 v173, v28, v29
  v_mfma_f32_16x16x32_bf16 v[84:87], a[148:151], a[100:103], v[84:87]
  v_exp_f32 v26, v108
  v_mfma_f32_16x16x32_bf16 v[84:87], a[152:155], a[104:107], v[84:87]
  ds_read_b64_tr_b16 a[186:187], v19 offset:20480
  v_mfma_f32_16x16x32_bf16 v[84:87], a[156:159], a[108:111], v[84:87]
  v_exp_f32 v27, v109
  v_mfma_f32_16x16x32_bf16 v[92:95], a[144:147], a[112:115], v[140:143]
  ds_read_b64_tr_b16 a[188:189], v19 offset:24576
  v_cvt_pk_bf16_f32 v174, v26, v27
  v_mfma_f32_16x16x32_bf16 v[92:95], a[148:151], a[116:119], v[92:95]
  v_exp_f32 v28, v110
  v_mfma_f32_16x16x32_bf16 v[92:95], a[152:155], a[120:123], v[92:95]
  ds_read_b64_tr_b16 a[190:191], v19 offset:28672
  v_mfma_f32_16x16x32_bf16 v[92:95], a[156:159], a[124:127], v[92:95]
  v_exp_f32 v29, v111
  v_smfmac_f32_16x16x64_bf16 v[40:43], a[236:239], v[144:151], v1
  s_waitcnt lgkmcnt(8)
  v_smfmac_f32_16x16x64_bf16 v[44:47], a[236:239], v[152:159], v1
  v_cvt_pk_bf16_f32 v175, v28, v29
  v_mfma_f32_16x16x32_bf16 a[16:19], a[160:163], v[48:51], a[16:19]
  ds_read_b128 a[128:131], v8 offset:24576
  v_mfma_f32_16x16x32_bf16 a[16:19], a[164:167], v[52:55], a[16:19]
  v_exp_f32 v26, v112
  v_mfma_f32_16x16x32_bf16 a[48:51], a[160:163], v[56:59], a[48:51]
  ds_read_b128 a[132:135], v9 offset:24576
  v_mfma_f32_16x16x32_bf16 a[48:51], a[164:167], v[60:63], a[48:51]
  v_exp_f32 v27, v113
  v_mfma_f32_16x16x32_bf16 v[208:211], a[160:163], v[144:147], v[208:211]
  ds_read_b128 a[136:139], v10 offset:24576
  v_cvt_pk_bf16_f32 v180, v26, v27
  v_mfma_f32_16x16x32_bf16 v[208:211], a[164:167], v[148:151], v[208:211]
  v_exp_f32 v28, v114
  v_mfma_f32_16x16x32_bf16 v[240:243], a[160:163], v[152:155], v[240:243]
  ds_read_b128 a[140:143], v11 offset:24576
  v_mfma_f32_16x16x32_bf16 v[240:243], a[164:167], v[156:159], v[240:243]
  v_exp_f32 v29, v115
  v_mfma_f32_16x16x32_bf16 a[20:23], a[168:171], v[48:51], a[20:23]
  ds_read_b128 a[144:147], v8 offset:28672
  v_cvt_pk_bf16_f32 v181, v28, v29
  v_mfma_f32_16x16x32_bf16 a[20:23], a[172:175], v[52:55], a[20:23]
  v_exp_f32 v26, v116
  v_mfma_f32_16x16x32_bf16 a[52:55], a[168:171], v[56:59], a[52:55]
  ds_read_b128 a[148:151], v9 offset:28672
  v_mfma_f32_16x16x32_bf16 a[52:55], a[172:175], v[60:63], a[52:55]
  s_add_u32 m0, s54, 16384
  v_exp_f32 v27, v117
  v_mfma_f32_16x16x32_bf16 v[212:215], a[168:171], v[144:147], v[212:215]
  ds_read_b128 a[152:155], v10 offset:28672
  v_cvt_pk_bf16_f32 v182, v26, v27
  v_mfma_f32_16x16x32_bf16 v[212:215], a[172:175], v[148:151], v[212:215]
  s_add_u32 s46, s46, 8192
  v_exp_f32 v28, v118
  v_mfma_f32_16x16x32_bf16 v[244:247], a[168:171], v[152:155], v[244:247]
  ds_read_b128 a[156:159], v11 offset:28672
  v_mfma_f32_16x16x32_bf16 v[244:247], a[172:175], v[156:159], v[244:247]
  s_waitcnt lgkmcnt(8)
  v_exp_f32 v29, v119
  v_mfma_f32_16x16x32_bf16 a[24:27], a[176:179], v[48:51], a[24:27]
  v_cvt_pk_bf16_f32 v183, v28, v29
  v_mfma_f32_16x16x32_bf16 a[24:27], a[180:183], v[52:55], a[24:27]
  v_exp_f32 v26, v120
  v_mfma_f32_16x16x32_bf16 a[56:59], a[176:179], v[56:59], a[56:59]
  buffer_load_dwordx4 v6, s[20:23], s46 offen offset:0 nt lds
  v_mfma_f32_16x16x32_bf16 a[56:59], a[180:183], v[60:63], a[56:59]
  v_exp_f32 v27, v121
  v_mfma_f32_16x16x32_bf16 v[216:219], a[176:179], v[144:147], v[216:219]
  v_cvt_pk_bf16_f32 v188, v26, v27
  v_mfma_f32_16x16x32_bf16 v[216:219], a[180:183], v[148:151], v[216:219]
  v_exp_f32 v28, v122
  v_mfma_f32_16x16x32_bf16 v[248:251], a[176:179], v[152:155], v[248:251]
  buffer_load_dwordx4 v7, s[20:23], s46 offen offset:1024 nt lds
  v_mfma_f32_16x16x32_bf16 v[248:251], a[180:183], v[156:159], v[248:251]
  s_add_u32 m0, s54, 24576
  v_exp_f32 v29, v123
  v_mfma_f32_16x16x32_bf16 a[28:31], a[184:187], v[48:51], a[28:31]
  v_cvt_pk_bf16_f32 v189, v28, v29
  v_mfma_f32_16x16x32_bf16 a[28:31], a[188:191], v[52:55], a[28:31]
  s_add_u32 s46, s46, 8192
  v_exp_f32 v26, v124
  v_mfma_f32_16x16x32_bf16 a[60:63], a[184:187], v[56:59], a[60:63]
  buffer_load_dwordx4 v6, s[20:23], s46 offen offset:0 nt lds
  v_mfma_f32_16x16x32_bf16 a[60:63], a[188:191], v[60:63], a[60:63]
  s_xor_b32 s54, s54, s53
  v_exp_f32 v27, v125
  v_mfma_f32_16x16x32_bf16 v[220:223], a[184:187], v[144:147], v[220:223]
  v_cvt_pk_bf16_f32 v190, v26, v27
  v_mfma_f32_16x16x32_bf16 v[220:223], a[188:191], v[148:151], v[220:223]
  v_exp_f32 v28, v126
  v_mfma_f32_16x16x32_bf16 v[252:255], a[184:187], v[152:155], v[252:255]
  buffer_load_dwordx4 v7, s[20:23], s46 offen offset:1024 nt lds
  v_mfma_f32_16x16x32_bf16 v[252:255], a[188:191], v[156:159], v[252:255]
  s_waitcnt lgkmcnt(0)
  v_exp_f32 v29, v127
  v_mfma_f32_16x16x32_bf16 v[96:99], a[128:131], a[64:67], v[128:131]
  ds_read_b64_tr_b16 a[160:161], v12 offset:0
  v_cvt_pk_bf16_f32 v191, v28, v29
  v_mfma_f32_16x16x32_bf16 v[96:99], a[132:135], a[68:71], v[96:99]
  v_exp_f32 v26, v64
  v_mfma_f32_16x16x32_bf16 v[96:99], a[136:139], a[72:75], v[96:99]
  ds_read_b64_tr_b16 a[162:163], v12 offset:4096
  v_xor_b32 v8, s53, v8
  v_mfma_f32_16x16x32_bf16 v[96:99], a[140:143], a[76:79], v[96:99]
  v_exp_f32 v27, v65
  v_mfma_f32_16x16x32_bf16 v[104:107], a[128:131], a[80:83], v[132:135]
  ds_read_b64_tr_b16 a[164:165], v12 offset:8192
  v_cvt_pk_bf16_f32 v48, v26, v27
  v_mfma_f32_16x16x32_bf16 v[104:107], a[132:135], a[84:87], v[104:107]
  v_exp_f32 v28, v66
  v_mfma_f32_16x16x32_bf16 v[104:107], a[136:139], a[88:91], v[104:107]
  ds_read_b64_tr_b16 a[166:167], v12 offset:12288
  v_xor_b32 v9, s53, v9
  v_mfma_f32_16x16x32_bf16 v[104:107], a[140:143], a[92:95], v[104:107]
  v_exp_f32 v29, v67
  v_mfma_f32_16x16x32_bf16 v[112:115], a[128:131], a[96:99], v[136:139]
  ds_read_b64_tr_b16 a[168:169], v13 offset:0
  v_cvt_pk_bf16_f32 v49, v28, v29
  v_mfma_f32_16x16x32_bf16 v[112:115], a[132:135], a[100:103], v[112:115]
  v_exp_f32 v26, v68
  v_mfma_f32_16x16x32_bf16 v[112:115], a[136:139], a[104:107], v[112:115]
  ds_read_b64_tr_b16 a[170:171], v13 offset:4096
  v_xor_b32 v10, s53, v10
  v_mfma_f32_16x16x32_bf16 v[112:115], a[140:143], a[108:111], v[112:115]
  v_exp_f32 v27, v69
  v_mfma_f32_16x16x32_bf16 v[120:123], a[128:131], a[112:115], v[140:143]
  ds_read_b64_tr_b16 a[172:173], v13 offset:8192
  v_cvt_pk_bf16_f32 v50, v26, v27
  v_mfma_f32_16x16x32_bf16 v[120:123], a[132:135], a[116:119], v[120:123]
  v_exp_f32 v28, v70
  v_mfma_f32_16x16x32_bf16 v[120:123], a[136:139], a[120:123], v[120:123]
  ds_read_b64_tr_b16 a[174:175], v13 offset:12288
  v_xor_b32 v11, s53, v11
  v_mfma_f32_16x16x32_bf16 v[120:123], a[140:143], a[124:127], v[120:123]
  v_exp_f32 v29, v71
  v_mfma_f32_16x16x32_bf16 v[100:103], a[144:147], a[64:67], v[128:131]
  ds_read_b64_tr_b16 a[176:177], v14 offset:0
  v_cvt_pk_bf16_f32 v51, v28, v29
  v_mfma_f32_16x16x32_bf16 v[100:103], a[148:151], a[68:71], v[100:103]
  v_exp_f32 v26, v72
  v_mfma_f32_16x16x32_bf16 v[100:103], a[152:155], a[72:75], v[100:103]
  ds_read_b64_tr_b16 a[178:179], v14 offset:4096
  v_xor_b32 v16, s53, v16
  v_mfma_f32_16x16x32_bf16 v[100:103], a[156:159], a[76:79], v[100:103]
  v_exp_f32 v27, v73
  v_mfma_f32_16x16x32_bf16 v[108:111], a[144:147], a[80:83], v[132:135]
  ds_read_b64_tr_b16 a[180:181], v14 offset:8192
  v_cvt_pk_bf16_f32 v56, v26, v27
  v_mfma_f32_16x16x32_bf16 v[108:111], a[148:151], a[84:87], v[108:111]
  v_exp_f32 v28, v74
  v_mfma_f32_16x16x32_bf16 v[108:111], a[152:155], a[88:91], v[108:111]
  ds_read_b64_tr_b16 a[182:183], v14 offset:12288
  v_xor_b32 v17, s53, v17
  v_mfma_f32_16x16x32_bf16 v[108:111], a[156:159], a[92:95], v[108:111]
  v_exp_f32 v29, v75
  v_mfma_f32_16x16x32_bf16 v[116:119], a[144:147], a[96:99], v[136:139]
  ds_read_b64_tr_b16 a[184:185], v15 offset:0
  v_cvt_pk_bf16_f32 v57, v28, v29
  v_mfma_f32_16x16x32_bf16 v[116:119], a[148:151], a[100:103], v[116:119]
  v_exp_f32 v26, v76
  v_mfma_f32_16x16x32_bf16 v[116:119], a[152:155], a[104:107], v[116:119]
  ds_read_b64_tr_b16 a[186:187], v15 offset:4096
  v_xor_b32 v18, s53, v18
  v_mfma_f32_16x16x32_bf16 v[116:119], a[156:159], a[108:111], v[116:119]
  v_exp_f32 v27, v77
  v_mfma_f32_16x16x32_bf16 v[124:127], a[144:147], a[112:115], v[140:143]
  ds_read_b64_tr_b16 a[188:189], v15 offset:8192
  v_cvt_pk_bf16_f32 v58, v26, v27
  v_mfma_f32_16x16x32_bf16 v[124:127], a[148:151], a[116:119], v[124:127]
  v_exp_f32 v28, v78
  v_mfma_f32_16x16x32_bf16 v[124:127], a[152:155], a[120:123], v[124:127]
  ds_read_b64_tr_b16 a[190:191], v15 offset:12288
  v_xor_b32 v19, s53, v19
  v_mfma_f32_16x16x32_bf16 v[124:127], a[156:159], a[124:127], v[124:127]
  s_waitcnt vmcnt(8) lgkmcnt(8)
  v_exp_f32 v29, v79
  v_smfmac_f32_16x16x64_bf16 v[32:35], a[236:239], v[160:167], v1
  s_barrier
  v_smfmac_f32_16x16x64_bf16 v[36:39], a[236:239], v[168:175], v1
  v_cvt_pk_bf16_f32 v59, v28, v29
  v_mfma_f32_16x16x32_bf16 a[0:3], a[160:163], v[160:163], a[0:3]
  ds_read_b128 a[128:131], v8 offset:0
  v_mfma_f32_16x16x32_bf16 a[0:3], a[164:167], v[164:167], a[0:3]
  v_exp_f32 v26, v80
  v_mfma_f32_16x16x32_bf16 a[32:35], a[160:163], v[168:171], a[32:35]
  ds_read_b128 a[132:135], v9 offset:0
  v_mfma_f32_16x16x32_bf16 a[32:35], a[164:167], v[172:175], a[32:35]
  v_exp_f32 v27, v81
  v_mfma_f32_16x16x32_bf16 v[192:195], a[160:163], v[176:179], v[192:195]
  ds_read_b128 a[136:139], v10 offset:0
  v_cvt_pk_bf16_f32 v144, v26, v27
  v_mfma_f32_16x16x32_bf16 v[192:195], a[164:167], v[180:183], v[192:195]
  v_exp_f32 v28, v82
  v_mfma_f32_16x16x32_bf16 v[224:227], a[160:163], v[184:187], v[224:227]
  ds_read_b128 a[140:143], v11 offset:0
  v_mfma_f32_16x16x32_bf16 v[224:227], a[164:167], v[188:191], v[224:227]
  v_exp_f32 v29, v83
  v_mfma_f32_16x16x32_bf16 a[4:7], a[168:171], v[160:163], a[4:7]
  ds_read_b128 a[144:147], v8 offset:4096
  v_cvt_pk_bf16_f32 v145, v28, v29
  v_mfma_f32_16x16x32_bf16 a[4:7], a[172:175], v[164:167], a[4:7]
  v_exp_f32 v26, v84
  v_mfma_f32_16x16x32_bf16 a[36:39], a[168:171], v[168:171], a[36:39]
  ds_read_b128 a[148:151], v9 offset:4096
  v_mfma_f32_16x16x32_bf16 a[36:39], a[172:175], v[172:175], a[36:39]
  s_add_u32 m0, s55, 16384
  v_exp_f32 v27, v85
  v_mfma_f32_16x16x32_bf16 v[196:199], a[168:171], v[176:179], v[196:199]
  ds_read_b128 a[152:155], v10 offset:4096
  v_cvt_pk_bf16_f32 v146, v26, v27
  v_mfma_f32_16x16x32_bf16 v[196:199], a[172:175], v[180:183], v[196:199]
  s_add_u32 s33, s33, 8192
  v_exp_f32 v28, v86
  v_mfma_f32_16x16x32_bf16 v[228:231], a[168:171], v[184:187], v[228:231]
  ds_read_b128 a[156:159], v11 offset:4096
  v_mfma_f32_16x16x32_bf16 v[228:231], a[172:175], v[188:191], v[228:231]
  s_waitcnt lgkmcnt(8)
  v_exp_f32 v29, v87
  v_mfma_f32_16x16x32_bf16 a[8:11], a[176:179], v[160:163], a[8:11]
  v_cvt_pk_bf16_f32 v147, v28, v29
  v_mfma_f32_16x16x32_bf16 a[8:11], a[180:183], v[164:167], a[8:11]
  v_exp_f32 v26, v88
  v_mfma_f32_16x16x32_bf16 a[40:43], a[176:179], v[168:171], a[40:43]
  buffer_load_dwordx4 v24, s[24:27], s33 offen offset:0 nt lds
  v_mfma_f32_16x16x32_bf16 a[40:43], a[180:183], v[172:175], a[40:43]
  v_exp_f32 v27, v89
  v_mfma_f32_16x16x32_bf16 v[200:203], a[176:179], v[176:179], v[200:203]
  v_cvt_pk_bf16_f32 v152, v26, v27
  v_mfma_f32_16x16x32_bf16 v[200:203], a[180:183], v[180:183], v[200:203]
  v_exp_f32 v28, v90
  v_mfma_f32_16x16x32_bf16 v[232:235], a[176:179], v[184:187], v[232:235]
  buffer_load_dwordx4 v25, s[24:27], s33 offen offset:1024 nt lds
  v_mfma_f32_16x16x32_bf16 v[232:235], a[180:183], v[188:191], v[232:235]
  s_add_u32 m0, s55, 24576
  v_exp_f32 v29, v91
  v_mfma_f32_16x16x32_bf16 a[12:15], a[184:187], v[160:163], a[12:15]
  v_cvt_pk_bf16_f32 v153, v28, v29
  v_mfma_f32_16x16x32_bf16 a[12:15], a[188:191], v[164:167], a[12:15]
  s_add_u32 s33, s33, 8192
  v_exp_f32 v26, v92
  v_mfma_f32_16x16x32_bf16 a[44:47], a[184:187], v[168:171], a[44:47]
  buffer_load_dwordx4 v24, s[24:27], s33 offen offset:0 nt lds
  v_mfma_f32_16x16x32_bf16 a[44:47], a[188:191], v[172:175], a[44:47]
  v_exp_f32 v27, v93
  v_mfma_f32_16x16x32_bf16 v[204:207], a[184:187], v[176:179], v[204:207]
  v_cvt_pk_bf16_f32 v154, v26, v27
  v_mfma_f32_16x16x32_bf16 v[204:207], a[188:191], v[180:183], v[204:207]
  v_exp_f32 v28, v94
  v_mfma_f32_16x16x32_bf16 v[236:239], a[184:187], v[184:187], v[236:239]
  buffer_load_dwordx4 v25, s[24:27], s33 offen offset:1024 nt lds
  v_mfma_f32_16x16x32_bf16 v[236:239], a[188:191], v[188:191], v[236:239]
  s_waitcnt lgkmcnt(0)
  v_exp_f32 v29, v95
  v_mfma_f32_16x16x32_bf16 v[64:67], a[128:131], a[64:67], v[128:131]
  ds_read_b64_tr_b16 a[160:161], v16 offset:0
  v_cvt_pk_bf16_f32 v155, v28, v29
  v_mfma_f32_16x16x32_bf16 v[64:67], a[132:135], a[68:71], v[64:67]
  v_exp_f32 v26, v96
  v_mfma_f32_16x16x32_bf16 v[64:67], a[136:139], a[72:75], v[64:67]
  ds_read_b64_tr_b16 a[162:163], v16 offset:4096
  v_mfma_f32_16x16x32_bf16 v[64:67], a[140:143], a[76:79], v[64:67]
  v_exp_f32 v27, v97
  v_mfma_f32_16x16x32_bf16 v[72:75], a[128:131], a[80:83], v[132:135]
  ds_read_b64_tr_b16 a[164:165], v16 offset:8192
  v_cvt_pk_bf16_f32 v52, v26, v27
  v_mfma_f32_16x16x32_bf16 v[72:75], a[132:135], a[84:87], v[72:75]
  v_exp_f32 v28, v98
  v_mfma_f32_16x16x32_bf16 v[72:75], a[136:139], a[88:91], v[72:75]
  ds_read_b64_tr_b16 a[166:167], v16 offset:12288
  v_mfma_f32_16x16x32_bf16 v[72:75], a[140:143], a[92:95], v[72:75]
  v_exp_f32 v29, v99
  v_mfma_f32_16x16x32_bf16 v[80:83], a[128:131], a[96:99], v[136:139]
  ds_read_b64_tr_b16 a[168:169], v17 offset:0
  v_cvt_pk_bf16_f32 v53, v28, v29
  v_mfma_f32_16x16x32_bf16 v[80:83], a[132:135], a[100:103], v[80:83]
  v_exp_f32 v26, v100
  v_mfma_f32_16x16x32_bf16 v[80:83], a[136:139], a[104:107], v[80:83]
  ds_read_b64_tr_b16 a[170:171], v17 offset:4096
  v_mfma_f32_16x16x32_bf16 v[80:83], a[140:143], a[108:111], v[80:83]
  v_exp_f32 v27, v101
  v_mfma_f32_16x16x32_bf16 v[88:91], a[128:131], a[112:115], v[140:143]
  ds_read_b64_tr_b16 a[172:173], v17 offset:8192
  v_cvt_pk_bf16_f32 v54, v26, v27
  v_mfma_f32_16x16x32_bf16 v[88:91], a[132:135], a[116:119], v[88:91]
  v_exp_f32 v28, v102
  v_mfma_f32_16x16x32_bf16 v[88:91], a[136:139], a[120:123], v[88:91]
  ds_read_b64_tr_b16 a[174:175], v17 offset:12288
  v_mfma_f32_16x16x32_bf16 v[88:91], a[140:143], a[124:127], v[88:91]
  v_exp_f32 v29, v103
  v_mfma_f32_16x16x32_bf16 v[68:71], a[144:147], a[64:67], v[128:131]
  ds_read_b64_tr_b16 a[176:177], v18 offset:0
  v_cvt_pk_bf16_f32 v55, v28, v29
  v_mfma_f32_16x16x32_bf16 v[68:71], a[148:151], a[68:71], v[68:71]
  v_exp_f32 v26, v104
  v_mfma_f32_16x16x32_bf16 v[68:71], a[152:155], a[72:75], v[68:71]
  ds_read_b64_tr_b16 a[178:179], v18 offset:4096
  v_mfma_f32_16x16x32_bf16 v[68:71], a[156:159], a[76:79], v[68:71]
  v_exp_f32 v27, v105
  v_mfma_f32_16x16x32_bf16 v[76:79], a[144:147], a[80:83], v[132:135]
  ds_read_b64_tr_b16 a[180:181], v18 offset:8192
  v_cvt_pk_bf16_f32 v60, v26, v27
  v_mfma_f32_16x16x32_bf16 v[76:79], a[148:151], a[84:87], v[76:79]
  v_exp_f32 v28, v106
  v_mfma_f32_16x16x32_bf16 v[76:79], a[152:155], a[88:91], v[76:79]
  ds_read_b64_tr_b16 a[182:183], v18 offset:12288
  v_mfma_f32_16x16x32_bf16 v[76:79], a[156:159], a[92:95], v[76:79]
  v_exp_f32 v29, v107
  v_mfma_f32_16x16x32_bf16 v[84:87], a[144:147], a[96:99], v[136:139]
  ds_read_b64_tr_b16 a[184:185], v19 offset:0
  v_cvt_pk_bf16_f32 v61, v28, v29
  v_mfma_f32_16x16x32_bf16 v[84:87], a[148:151], a[100:103], v[84:87]
  v_exp_f32 v26, v108
  v_mfma_f32_16x16x32_bf16 v[84:87], a[152:155], a[104:107], v[84:87]
  ds_read_b64_tr_b16 a[186:187], v19 offset:4096
  v_mfma_f32_16x16x32_bf16 v[84:87], a[156:159], a[108:111], v[84:87]
  v_exp_f32 v27, v109
  v_mfma_f32_16x16x32_bf16 v[92:95], a[144:147], a[112:115], v[140:143]
  ds_read_b64_tr_b16 a[188:189], v19 offset:8192
  v_cvt_pk_bf16_f32 v62, v26, v27
  v_mfma_f32_16x16x32_bf16 v[92:95], a[148:151], a[116:119], v[92:95]
  v_exp_f32 v28, v110
  v_mfma_f32_16x16x32_bf16 v[92:95], a[152:155], a[120:123], v[92:95]
  ds_read_b64_tr_b16 a[190:191], v19 offset:12288
  v_mfma_f32_16x16x32_bf16 v[92:95], a[156:159], a[124:127], v[92:95]
  v_exp_f32 v29, v111
  v_smfmac_f32_16x16x64_bf16 v[40:43], a[236:239], v[176:183], v1
  s_waitcnt lgkmcnt(8)
  v_smfmac_f32_16x16x64_bf16 v[44:47], a[236:239], v[184:191], v1
  v_cvt_pk_bf16_f32 v63, v28, v29
  v_mfma_f32_16x16x32_bf16 a[16:19], a[160:163], v[160:163], a[16:19]
  ds_read_b128 a[128:131], v8 offset:8192
  v_mfma_f32_16x16x32_bf16 a[16:19], a[164:167], v[164:167], a[16:19]
  v_exp_f32 v26, v112
  v_mfma_f32_16x16x32_bf16 a[48:51], a[160:163], v[168:171], a[48:51]
  ds_read_b128 a[132:135], v9 offset:8192
  v_mfma_f32_16x16x32_bf16 a[48:51], a[164:167], v[172:175], a[48:51]
  v_exp_f32 v27, v113
  v_mfma_f32_16x16x32_bf16 v[208:211], a[160:163], v[176:179], v[208:211]
  ds_read_b128 a[136:139], v10 offset:8192
  v_cvt_pk_bf16_f32 v148, v26, v27
  v_mfma_f32_16x16x32_bf16 v[208:211], a[164:167], v[180:183], v[208:211]
  v_exp_f32 v28, v114
  v_mfma_f32_16x16x32_bf16 v[240:243], a[160:163], v[184:187], v[240:243]
  ds_read_b128 a[140:143], v11 offset:8192
  v_mfma_f32_16x16x32_bf16 v[240:243], a[164:167], v[188:191], v[240:243]
  v_exp_f32 v29, v115
  v_mfma_f32_16x16x32_bf16 a[20:23], a[168:171], v[160:163], a[20:23]
  ds_read_b128 a[144:147], v8 offset:12288
  v_cvt_pk_bf16_f32 v149, v28, v29
  v_mfma_f32_16x16x32_bf16 a[20:23], a[172:175], v[164:167], a[20:23]
  v_exp_f32 v26, v116
  v_mfma_f32_16x16x32_bf16 a[52:55], a[168:171], v[168:171], a[52:55]
  ds_read_b128 a[148:151], v9 offset:12288
  v_mfma_f32_16x16x32_bf16 a[52:55], a[172:175], v[172:175], a[52:55]
  s_mov_b32 m0, s54
  v_exp_f32 v27, v117
  v_mfma_f32_16x16x32_bf16 v[212:215], a[168:171], v[176:179], v[212:215]
  ds_read_b128 a[152:155], v10 offset:12288
  v_cvt_pk_bf16_f32 v150, v26, v27
  v_mfma_f32_16x16x32_bf16 v[212:215], a[172:175], v[180:183], v[212:215]
  s_add_u32 s46, s46, 8192
  v_exp_f32 v28, v118
  v_mfma_f32_16x16x32_bf16 v[244:247], a[168:171], v[184:187], v[244:247]
  ds_read_b128 a[156:159], v11 offset:12288
  v_mfma_f32_16x16x32_bf16 v[244:247], a[172:175], v[188:191], v[244:247]
  s_waitcnt lgkmcnt(8)
  v_exp_f32 v29, v119
  v_mfma_f32_16x16x32_bf16 a[24:27], a[176:179], v[160:163], a[24:27]
  v_cvt_pk_bf16_f32 v151, v28, v29
  v_mfma_f32_16x16x32_bf16 a[24:27], a[180:183], v[164:167], a[24:27]
  v_exp_f32 v26, v120
  v_mfma_f32_16x16x32_bf16 a[56:59], a[176:179], v[168:171], a[56:59]
  buffer_load_dwordx4 v6, s[20:23], s46 offen offset:0 nt lds
  v_mfma_f32_16x16x32_bf16 a[56:59], a[180:183], v[172:175], a[56:59]
  v_exp_f32 v27, v121
  v_mfma_f32_16x16x32_bf16 v[216:219], a[176:179], v[176:179], v[216:219]
  v_cvt_pk_bf16_f32 v156, v26, v27
  v_mfma_f32_16x16x32_bf16 v[216:219], a[180:183], v[180:183], v[216:219]
  s_xor_b32 s55, s55, s53
  v_exp_f32 v28, v122
  v_mfma_f32_16x16x32_bf16 v[248:251], a[176:179], v[184:187], v[248:251]
  buffer_load_dwordx4 v7, s[20:23], s46 offen offset:1024 nt lds
  v_mfma_f32_16x16x32_bf16 v[248:251], a[180:183], v[188:191], v[248:251]
  s_add_u32 m0, s54, 8192
  v_exp_f32 v29, v123
  v_mfma_f32_16x16x32_bf16 a[28:31], a[184:187], v[160:163], a[28:31]
  v_cvt_pk_bf16_f32 v157, v28, v29
  v_mfma_f32_16x16x32_bf16 a[28:31], a[188:191], v[164:167], a[28:31]
  s_add_u32 s46, s46, 8192
  v_exp_f32 v26, v124
  v_mfma_f32_16x16x32_bf16 a[60:63], a[184:187], v[168:171], a[60:63]
  buffer_load_dwordx4 v6, s[20:23], s46 offen offset:0 nt lds
  v_mfma_f32_16x16x32_bf16 a[60:63], a[188:191], v[172:175], a[60:63]
  v_exp_f32 v27, v125
  v_mfma_f32_16x16x32_bf16 v[220:223], a[184:187], v[176:179], v[220:223]
  v_cvt_pk_bf16_f32 v158, v26, v27
  v_mfma_f32_16x16x32_bf16 v[220:223], a[188:191], v[180:183], v[220:223]
  s_add_u32 s60, s60, 1
  s_cmp_lt_u32 s60, 5
  v_exp_f32 v28, v126
  v_mfma_f32_16x16x32_bf16 v[252:255], a[184:187], v[184:187], v[252:255]
  buffer_load_dwordx4 v7, s[20:23], s46 offen offset:1024 nt lds
  v_mfma_f32_16x16x32_bf16 v[252:255], a[188:191], v[188:191], v[252:255]
  s_waitcnt lgkmcnt(0)
  v_exp_f32 v29, v127
  s_cbranch_scc1 L_loop
  v_mfma_f32_16x16x32_bf16 v[96:99], a[128:131], a[64:67], v[128:131]
  v_cvt_pk_bf16_f32 v159, v28, v29
  v_mfma_f32_16x16x32_bf16 v[96:99], a[132:135], a[68:71], v[96:99]
  v_exp_f32 v26, v64
  v_mfma_f32_16x16x32_bf16 v[96:99], a[136:139], a[72:75], v[96:99]
  ds_read_b64_tr_b16 a[160:161], v12 offset:16384
  ds_read_b64_tr_b16 a[162:163], v12 offset:20480
  ds_read_b64_tr_b16 a[164:165], v12 offset:24576
  v_mfma_f32_16x16x32_bf16 v[96:99], a[140:143], a[76:79], v[96:99]
  v_exp_f32 v27, v65
  v_mfma_f32_16x16x32_bf16 v[104:107], a[128:131], a[80:83], v[132:135]
  ds_read_b64_tr_b16 a[166:167], v12 offset:28672
  ds_read_b64_tr_b16 a[168:169], v13 offset:16384
  v_cvt_pk_bf16_f32 v160, v26, v27
  v_mfma_f32_16x16x32_bf16 v[104:107], a[132:135], a[84:87], v[104:107]
  v_exp_f32 v28, v66
  v_mfma_f32_16x16x32_bf16 v[104:107], a[136:139], a[88:91], v[104:107]
  ds_read_b64_tr_b16 a[170:171], v13 offset:20480
  ds_read_b64_tr_b16 a[172:173], v13 offset:24576
  ds_read_b64_tr_b16 a[174:175], v13 offset:28672
  v_mfma_f32_16x16x32_bf16 v[104:107], a[140:143], a[92:95], v[104:107]
  v_exp_f32 v29, v67
  v_mfma_f32_16x16x32_bf16 v[100:103], a[144:147], a[64:67], v[128:131]
  ds_read_b64_tr_b16 a[176:177], v14 offset:16384
  ds_read_b64_tr_b16 a[178:179], v14 offset:20480
  v_cvt_pk_bf16_f32 v161, v28, v29
  v_mfma_f32_16x16x32_bf16 v[100:103], a[148:151], a[68:71], v[100:103]
  v_exp_f32 v26, v68
  v_mfma_f32_16x16x32_bf16 v[100:103], a[152:155], a[72:75], v[100:103]
  ds_read_b64_tr_b16 a[180:181], v14 offset:24576
  ds_read_b64_tr_b16 a[182:183], v14 offset:28672
  ds_read_b64_tr_b16 a[184:185], v15 offset:16384
  v_mfma_f32_16x16x32_bf16 v[100:103], a[156:159], a[76:79], v[100:103]
  v_exp_f32 v27, v69
  v_mfma_f32_16x16x32_bf16 v[108:111], a[144:147], a[80:83], v[132:135]
  ds_read_b64_tr_b16 a[186:187], v15 offset:20480
  v_cvt_pk_bf16_f32 v162, v26, v27
  v_mfma_f32_16x16x32_bf16 v[108:111], a[148:151], a[84:87], v[108:111]
  v_exp_f32 v28, v70
  v_mfma_f32_16x16x32_bf16 v[108:111], a[152:155], a[88:91], v[108:111]
  ds_read_b64_tr_b16 a[188:189], v15 offset:24576
  ds_read_b64_tr_b16 a[190:191], v15 offset:28672
  v_mfma_f32_16x16x32_bf16 v[108:111], a[156:159], a[92:95], v[108:111]
  s_waitcnt vmcnt(8) lgkmcnt(8)
  v_exp_f32 v29, v71
  v_smfmac_f32_16x16x64_bf16 v[32:35], a[236:239], v[48:55], v1
  s_barrier
  v_cvt_pk_bf16_f32 v163, v28, v29
  v_mfma_f32_16x16x32_bf16 a[0:3], a[160:163], v[48:51], a[0:3]
  v_exp_f32 v26, v72
  v_mfma_f32_16x16x32_bf16 a[0:3], a[164:167], v[52:55], a[0:3]
  ds_read_b128 a[196:199], v8 offset:16384
  ds_read_b128 a[200:203], v9 offset:16384
  v_mfma_f32_16x16x32_bf16 a[32:35], a[160:163], v[56:59], a[32:35]
  v_exp_f32 v27, v73
  v_mfma_f32_16x16x32_bf16 a[32:35], a[164:167], v[60:63], a[32:35]
  ds_read_b128 a[204:207], v10 offset:16384
  v_cvt_pk_bf16_f32 v168, v26, v27
  v_mfma_f32_16x16x32_bf16 a[4:7], a[168:171], v[48:51], a[4:7]
  v_exp_f32 v28, v74
  v_mfma_f32_16x16x32_bf16 a[4:7], a[172:175], v[52:55], a[4:7]
  ds_read_b128 a[208:211], v11 offset:16384
  ds_read_b128 a[212:215], v8 offset:20480
  v_mfma_f32_16x16x32_bf16 a[36:39], a[168:171], v[56:59], a[36:39]
  v_exp_f32 v29, v75
  v_mfma_f32_16x16x32_bf16 a[36:39], a[172:175], v[60:63], a[36:39]
  s_waitcnt lgkmcnt(5)
  ds_read_b128 a[216:219], v9 offset:20480
  v_cvt_pk_bf16_f32 v169, v28, v29
  v_mfma_f32_16x16x32_bf16 a[8:11], a[176:179], v[48:51], a[8:11]
  v_exp_f32 v26, v76
  v_mfma_f32_16x16x32_bf16 a[8:11], a[180:183], v[52:55], a[8:11]
  ds_read_b128 a[220:223], v10 offset:20480
  ds_read_b128 a[224:227], v11 offset:20480
  v_mfma_f32_16x16x32_bf16 a[40:43], a[176:179], v[56:59], a[40:43]
  v_exp_f32 v27, v77
  v_mfma_f32_16x16x32_bf16 a[40:43], a[180:183], v[60:63], a[40:43]
  v_cvt_pk_bf16_f32 v170, v26, v27
  v_mfma_f32_16x16x32_bf16 a[12:15], a[184:187], v[48:51], a[12:15]
  v_exp_f32 v28, v78
  v_mfma_f32_16x16x32_bf16 a[12:15], a[188:191], v[52:55], a[12:15]
  v_mfma_f32_16x16x32_bf16 a[44:47], a[184:187], v[56:59], a[44:47]
  v_exp_f32 v29, v79
  v_mfma_f32_16x16x32_bf16 a[44:47], a[188:191], v[60:63], a[44:47]
  s_waitcnt lgkmcnt(4)
  v_cvt_pk_bf16_f32 v171, v28, v29
  v_mfma_f32_16x16x32_bf16 v[64:67], a[196:199], a[64:67], v[128:131]
  ds_read_b64_tr_b16 a[128:129], v16 offset:16384
  ds_read_b64_tr_b16 a[130:131], v16 offset:20480
  v_mfma_f32_16x16x32_bf16 v[64:67], a[200:203], a[68:71], v[64:67]
  v_exp_f32 v26, v96
  v_mfma_f32_16x16x32_bf16 v[64:67], a[204:207], a[72:75], v[64:67]
  ds_read_b64_tr_b16 a[132:133], v16 offset:24576
  ds_read_b64_tr_b16 a[134:135], v16 offset:28672
  v_mfma_f32_16x16x32_bf16 v[64:67], a[208:211], a[76:79], v[64:67]
  v_exp_f32 v27, v97
  v_mfma_f32_16x16x32_bf16 v[72:75], a[196:199], a[80:83], v[132:135]
  ds_read_b64_tr_b16 a[136:137], v17 offset:16384
  v_cvt_pk_bf16_f32 v164, v26, v27
  v_mfma_f32_16x16x32_bf16 v[72:75], a[200:203], a[84:87], v[72:75]
  v_exp_f32 v28, v98
  v_mfma_f32_16x16x32_bf16 v[72:75], a[204:207], a[88:91], v[72:75]
L_isl4:
  s_cbranch_execz L_warm_done
  ds_read_b64_tr_b16 a[138:139], v17 offset:20480
  ds_read_b64_tr_b16 a[140:141], v17 offset:24576
  v_mfma_f32_16x16x32_bf16 v[72:75], a[208:211], a[92:95], v[72:75]
  s_waitcnt lgkmcnt(7)
  v_exp_f32 v29, v99
  v_mfma_f32_16x16x32_bf16 v[68:71], a[212:215], a[64:67], v[128:131]
  ds_read_b64_tr_b16 a[142:143], v17 offset:28672
  v_cvt_pk_bf16_f32 v165, v28, v29
  v_mfma_f32_16x16x32_bf16 v[68:71], a[216:219], a[68:71], v[68:71]
  v_exp_f32 v26, v100
  v_mfma_f32_16x16x32_bf16 v[68:71], a[220:223], a[72:75], v[68:71]
  ds_read_b64_tr_b16 a[144:145], v18 offset:16384
  ds_read_b64_tr_b16 a[146:147], v18 offset:20480
  v_mfma_f32_16x16x32_bf16 v[68:71], a[224:227], a[76:79], v[68:71]
  v_exp_f32 v27, v101
  v_mfma_f32_16x16x32_bf16 v[76:79], a[212:215], a[80:83], v[132:135]
  ds_read_b64_tr_b16 a[148:149], v18 offset:24576
  v_cvt_pk_bf16_f32 v166, v26, v27
  v_mfma_f32_16x16x32_bf16 v[76:79], a[216:219], a[84:87], v[76:79]
  v_exp_f32 v28, v102
  v_mfma_f32_16x16x32_bf16 v[76:79], a[220:223], a[88:91], v[76:79]
  ds_read_b64_tr_b16 a[150:151], v18 offset:28672
  ds_read_b64_tr_b16 a[152:153], v19 offset:16384
  v_mfma_f32_16x16x32_bf16 v[76:79], a[224:227], a[92:95], v[76:79]
  v_exp_f32 v29, v103
  v_smfmac_f32_16x16x64_bf16 v[36:39], a[236:239], v[56:63], v1
  s_waitcnt lgkmcnt(5)
  ds_read_b64_tr_b16 a[154:155], v19 offset:20480
  v_cvt_pk_bf16_f32 v167, v28, v29
  v_mfma_f32_16x16x32_bf16 a[16:19], a[128:131], v[48:51], a[16:19]
  v_exp_f32 v26, v104
  v_mfma_f32_16x16x32_bf16 a[16:19], a[132:135], v[52:55], a[16:19]
  ds_read_b64_tr_b16 a[156:157], v19 offset:24576
  ds_read_b64_tr_b16 a[158:159], v19 offset:28672
  v_mfma_f32_16x16x32_bf16 a[48:51], a[128:131], v[56:59], a[48:51]
  v_exp_f32 v27, v105
  v_mfma_f32_16x16x32_bf16 a[48:51], a[132:135], v[60:63], a[48:51]
  ds_read_b128 a[160:163], v8 offset:24576
  v_cvt_pk_bf16_f32 v172, v26, v27
  v_mfma_f32_16x16x32_bf16 a[20:23], a[136:139], v[48:51], a[20:23]
  v_exp_f32 v28, v106
  v_mfma_f32_16x16x32_bf16 a[20:23], a[140:143], v[52:55], a[20:23]
  ds_read_b128 a[164:167], v9 offset:24576
  ds_read_b128 a[168:171], v10 offset:24576
  v_mfma_f32_16x16x32_bf16 a[52:55], a[136:139], v[56:59], a[52:55]
  v_exp_f32 v29, v107
  v_mfma_f32_16x16x32_bf16 a[52:55], a[140:143], v[60:63], a[52:55]
  s_waitcnt lgkmcnt(3)
  ds_read_b128 a[172:175], v11 offset:24576
  v_cvt_pk_bf16_f32 v173, v28, v29
  v_mfma_f32_16x16x32_bf16 a[24:27], a[144:147], v[48:51], a[24:27]
  v_exp_f32 v26, v108
  v_mfma_f32_16x16x32_bf16 a[24:27], a[148:151], v[52:55], a[24:27]
  ds_read_b128 a[176:179], v8 offset:28672
  ds_read_b128 a[180:183], v9 offset:28672
  v_mfma_f32_16x16x32_bf16 a[56:59], a[144:147], v[56:59], a[56:59]
  v_exp_f32 v27, v109
  v_mfma_f32_16x16x32_bf16 a[56:59], a[148:151], v[60:63], a[56:59]
  ds_read_b128 a[184:187], v10 offset:28672
  v_cvt_pk_bf16_f32 v174, v26, v27
  v_mfma_f32_16x16x32_bf16 a[28:31], a[152:155], v[48:51], a[28:31]
  v_exp_f32 v28, v110
  v_mfma_f32_16x16x32_bf16 a[28:31], a[156:159], v[52:55], a[28:31]
  ds_read_b128 a[188:191], v11 offset:28672
  v_mfma_f32_16x16x32_bf16 a[60:63], a[152:155], v[56:59], a[60:63]
  v_exp_f32 v29, v111
  v_mfma_f32_16x16x32_bf16 a[60:63], a[156:159], v[60:63], a[60:63]
  s_waitcnt lgkmcnt(4)
  v_cvt_pk_bf16_f32 v175, v28, v29
  v_mfma_f32_16x16x32_bf16 v[96:99], a[160:163], a[64:67], v[128:131]
  ds_read_b64_tr_b16 a[196:197], v12 offset:32768
  ds_read_b64_tr_b16 a[198:199], v12 offset:36864
  ds_read_b64_tr_b16 a[200:201], v12 offset:40960
  v_mfma_f32_16x16x32_bf16 v[96:99], a[164:167], a[68:71], v[96:99]
  v_exp_f32 v26, v64
  v_mfma_f32_16x16x32_bf16 v[96:99], a[168:171], a[72:75], v[96:99]
  ds_read_b64_tr_b16 a[202:203], v12 offset:45056
  ds_read_b64_tr_b16 a[204:205], v13 offset:32768
  ds_read_b64_tr_b16 a[206:207], v13 offset:36864
  v_mfma_f32_16x16x32_bf16 v[96:99], a[172:175], a[76:79], v[96:99]
  v_exp_f32 v27, v65
  v_mfma_f32_16x16x32_bf16 v[104:107], a[160:163], a[80:83], v[132:135]
  ds_read_b64_tr_b16 a[208:209], v13 offset:40960
  ds_read_b64_tr_b16 a[210:211], v13 offset:45056
  v_cvt_pk_bf16_f32 v48, v26, v27
  v_mfma_f32_16x16x32_bf16 v[104:107], a[164:167], a[84:87], v[104:107]
  v_exp_f32 v28, v66
  v_mfma_f32_16x16x32_bf16 v[104:107], a[168:171], a[88:91], v[104:107]
  ds_read_b64_tr_b16 a[212:213], v14 offset:32768
  ds_read_b64_tr_b16 a[214:215], v14 offset:36864
  v_mfma_f32_16x16x32_bf16 v[104:107], a[172:175], a[92:95], v[104:107]
  s_waitcnt lgkmcnt(10)
  v_exp_f32 v29, v67
  v_mfma_f32_16x16x32_bf16 v[100:103], a[176:179], a[64:67], v[128:131]
  ds_read_b64_tr_b16 a[216:217], v14 offset:40960
  v_cvt_pk_bf16_f32 v49, v28, v29
  v_mfma_f32_16x16x32_bf16 v[100:103], a[180:183], a[68:71], v[100:103]
  v_exp_f32 v26, v68
  v_mfma_f32_16x16x32_bf16 v[100:103], a[184:187], a[72:75], v[100:103]
  ds_read_b64_tr_b16 a[218:219], v14 offset:45056
  ds_read_b64_tr_b16 a[220:221], v15 offset:32768
  v_mfma_f32_16x16x32_bf16 v[100:103], a[188:191], a[76:79], v[100:103]
  v_exp_f32 v27, v69
  v_mfma_f32_16x16x32_bf16 v[108:111], a[176:179], a[80:83], v[132:135]
  ds_read_b64_tr_b16 a[222:223], v15 offset:36864
  v_cvt_pk_bf16_f32 v50, v26, v27
  v_mfma_f32_16x16x32_bf16 v[108:111], a[180:183], a[84:87], v[108:111]
  v_exp_f32 v28, v70
  v_mfma_f32_16x16x32_bf16 v[108:111], a[184:187], a[88:91], v[108:111]
  ds_read_b64_tr_b16 a[224:225], v15 offset:40960
  ds_read_b64_tr_b16 a[226:227], v15 offset:45056
  v_mfma_f32_16x16x32_bf16 v[108:111], a[188:191], a[92:95], v[108:111]
  v_exp_f32 v29, v71
  v_smfmac_f32_16x16x64_bf16 v[32:35], a[236:239], v[160:167], v1
  s_waitcnt lgkmcnt(8)
  v_cvt_pk_bf16_f32 v51, v28, v29
  v_mfma_f32_16x16x32_bf16 a[0:3], a[196:199], v[160:163], a[0:3]
  v_exp_f32 v26, v72
  v_mfma_f32_16x16x32_bf16 a[0:3], a[200:203], v[164:167], a[0:3]
  ds_read_b64_tr_b16 a[128:129], v16 offset:32768
  ds_read_b64_tr_b16 a[130:131], v16 offset:36864
  ds_read_b64_tr_b16 a[132:133], v16 offset:40960
  v_mfma_f32_16x16x32_bf16 a[32:35], a[196:199], v[168:171], a[32:35]
  v_exp_f32 v27, v73
  v_mfma_f32_16x16x32_bf16 a[32:35], a[200:203], v[172:175], a[32:35]
  ds_read_b64_tr_b16 a[134:135], v16 offset:45056
  ds_read_b64_tr_b16 a[136:137], v17 offset:32768
  v_cvt_pk_bf16_f32 v56, v26, v27
  v_mfma_f32_16x16x32_bf16 a[4:7], a[204:207], v[160:163], a[4:7]
  v_exp_f32 v28, v74
  v_mfma_f32_16x16x32_bf16 a[4:7], a[208:211], v[164:167], a[4:7]
  ds_read_b64_tr_b16 a[138:139], v17 offset:36864
  ds_read_b64_tr_b16 a[140:141], v17 offset:40960
  ds_read_b64_tr_b16 a[142:143], v17 offset:45056
  v_mfma_f32_16x16x32_bf16 a[36:39], a[204:207], v[168:171], a[36:39]
  v_exp_f32 v29, v75
  v_mfma_f32_16x16x32_bf16 a[36:39], a[208:211], v[172:175], a[36:39]
  s_waitcnt lgkmcnt(8)
  ds_read_b64_tr_b16 a[144:145], v18 offset:32768
  ds_read_b64_tr_b16 a[146:147], v18 offset:36864
  v_cvt_pk_bf16_f32 v57, v28, v29
  v_mfma_f32_16x16x32_bf16 a[8:11], a[212:215], v[160:163], a[8:11]
  v_exp_f32 v26, v76
  v_mfma_f32_16x16x32_bf16 a[8:11], a[216:219], v[164:167], a[8:11]
  ds_read_b64_tr_b16 a[148:149], v18 offset:40960
  ds_read_b64_tr_b16 a[150:151], v18 offset:45056
  ds_read_b64_tr_b16 a[152:153], v19 offset:32768
  v_mfma_f32_16x16x32_bf16 a[40:43], a[212:215], v[168:171], a[40:43]
  v_exp_f32 v27, v77
  v_mfma_f32_16x16x32_bf16 a[40:43], a[216:219], v[172:175], a[40:43]
  ds_read_b64_tr_b16 a[154:155], v19 offset:36864
  v_cvt_pk_bf16_f32 v58, v26, v27
  v_mfma_f32_16x16x32_bf16 a[12:15], a[220:223], v[160:163], a[12:15]
  v_exp_f32 v28, v78
  v_mfma_f32_16x16x32_bf16 a[12:15], a[224:227], v[164:167], a[12:15]
  ds_read_b64_tr_b16 a[156:157], v19 offset:40960
  ds_read_b64_tr_b16 a[158:159], v19 offset:45056
  v_mfma_f32_16x16x32_bf16 a[44:47], a[220:223], v[168:171], a[44:47]
  v_exp_f32 v29, v79
  v_mfma_f32_16x16x32_bf16 a[44:47], a[224:227], v[172:175], a[44:47]
  s_waitcnt vmcnt(0) lgkmcnt(8)
  s_barrier
  v_cvt_pk_bf16_f32 v59, v28, v29
  v_smfmac_f32_16x16x64_bf16 v[36:39], a[236:239], v[168:175], v1
  ds_read_b64_tr_b16 a[160:161], v12 offset:49152
  v_exp_f32 v26, v96
  v_mfma_f32_16x16x32_bf16 a[16:19], a[128:131], v[160:163], a[16:19]
  ds_read_b64_tr_b16 a[162:163], v12 offset:53248
  v_exp_f32 v27, v97
  v_mfma_f32_16x16x32_bf16 a[16:19], a[132:135], v[164:167], a[16:19]
  v_cvt_pk_bf16_f32 v52, v26, v27
  v_exp_f32 v28, v98
  v_mfma_f32_16x16x32_bf16 a[48:51], a[128:131], v[168:171], a[48:51]
  ds_read_b64_tr_b16 a[164:165], v12 offset:57344
  v_exp_f32 v29, v99
  v_mfma_f32_16x16x32_bf16 a[48:51], a[132:135], v[172:175], a[48:51]
  v_cvt_pk_bf16_f32 v53, v28, v29
  v_exp_f32 v26, v100
  v_mfma_f32_16x16x32_bf16 a[20:23], a[136:139], v[160:163], a[20:23]
  ds_read_b64_tr_b16 a[166:167], v12 offset:61440
  v_exp_f32 v27, v101
  v_mfma_f32_16x16x32_bf16 a[20:23], a[140:143], v[164:167], a[20:23]
  v_cvt_pk_bf16_f32 v54, v26, v27
  v_exp_f32 v28, v102
  v_mfma_f32_16x16x32_bf16 a[52:55], a[136:139], v[168:171], a[52:55]
  ds_read_b64_tr_b16 a[168:169], v13 offset:49152
  v_exp_f32 v29, v103
  v_mfma_f32_16x16x32_bf16 a[52:55], a[140:143], v[172:175], a[52:55]
  s_waitcnt lgkmcnt(5)
  v_cvt_pk_bf16_f32 v55, v28, v29
  v_exp_f32 v26, v104
  v_mfma_f32_16x16x32_bf16 a[24:27], a[144:147], v[160:163], a[24:27]
  ds_read_b64_tr_b16 a[170:171], v13 offset:53248
  v_exp_f32 v27, v105
  v_mfma_f32_16x16x32_bf16 a[24:27], a[148:151], v[164:167], a[24:27]
  v_cvt_pk_bf16_f32 v60, v26, v27
  v_exp_f32 v28, v106
  v_mfma_f32_16x16x32_bf16 a[56:59], a[144:147], v[168:171], a[56:59]
  ds_read_b64_tr_b16 a[172:173], v13 offset:57344
  v_exp_f32 v29, v107
  v_mfma_f32_16x16x32_bf16 a[56:59], a[148:151], v[172:175], a[56:59]
  v_cvt_pk_bf16_f32 v61, v28, v29
  v_exp_f32 v26, v108
  v_mfma_f32_16x16x32_bf16 a[28:31], a[152:155], v[160:163], a[28:31]
  v_exp_f32 v27, v109
  v_mfma_f32_16x16x32_bf16 a[28:31], a[156:159], v[164:167], a[28:31]
  v_cvt_pk_bf16_f32 v62, v26, v27
  v_exp_f32 v28, v110
  v_mfma_f32_16x16x32_bf16 a[60:63], a[152:155], v[168:171], a[60:63]
  v_exp_f32 v29, v111
  v_mfma_f32_16x16x32_bf16 a[60:63], a[156:159], v[172:175], a[60:63]
  ds_read_b64_tr_b16 a[174:175], v13 offset:61440
  v_cvt_pk_bf16_f32 v63, v28, v29
  s_nop 1
  v_smfmac_f32_16x16x64_bf16 v[32:35], a[236:239], v[48:55], v1
  ds_read_b64_tr_b16 a[176:177], v14 offset:49152
  ds_read_b64_tr_b16 a[178:179], v14 offset:53248
  ds_read_b64_tr_b16 a[180:181], v14 offset:57344
  v_smfmac_f32_16x16x64_bf16 v[36:39], a[236:239], v[56:63], v1
  s_waitcnt lgkmcnt(3)
  ds_read_b64_tr_b16 a[182:183], v14 offset:61440
  ds_read_b64_tr_b16 a[184:185], v15 offset:49152
  v_mfma_f32_16x16x32_bf16 a[0:3], a[160:163], v[48:51], a[0:3]
  ds_read_b64_tr_b16 a[186:187], v15 offset:53248
  ds_read_b64_tr_b16 a[188:189], v15 offset:57344
  ds_read_b64_tr_b16 a[190:191], v15 offset:61440
  v_mfma_f32_16x16x32_bf16 a[0:3], a[164:167], v[52:55], a[0:3]
  ds_read_b64_tr_b16 a[196:197], v16 offset:49152
  ds_read_b64_tr_b16 a[198:199], v16 offset:53248
  v_mfma_f32_16x16x32_bf16 a[32:35], a[160:163], v[56:59], a[32:35]
  ds_read_b64_tr_b16 a[200:201], v16 offset:57344
  ds_read_b64_tr_b16 a[202:203], v16 offset:61440
  v_mfma_f32_16x16x32_bf16 a[32:35], a[164:167], v[60:63], a[32:35]
  ds_read_b64_tr_b16 a[204:205], v17 offset:49152
  ds_read_b64_tr_b16 a[206:207], v17 offset:53248
  ds_read_b64_tr_b16 a[208:209], v17 offset:57344
  v_mfma_f32_16x16x32_bf16 a[4:7], a[168:171], v[48:51], a[4:7]
  ds_read_b64_tr_b16 a[210:211], v17 offset:61440
  ds_read_b64_tr_b16 a[212:213], v18 offset:49152
  v_mfma_f32_16x16x32_bf16 a[4:7], a[172:175], v[52:55], a[4:7]
  ds_read_b64_tr_b16 a[214:215], v18 offset:53248
  ds_read_b64_tr_b16 a[216:217], v18 offset:57344
  ds_read_b64_tr_b16 a[218:219], v18 offset:61440
  v_mfma_f32_16x16x32_bf16 a[36:39], a[168:171], v[56:59], a[36:39]
  ds_read_b64_tr_b16 a[220:221], v19 offset:49152
  ds_read_b64_tr_b16 a[222:223], v19 offset:53248
  v_mfma_f32_16x16x32_bf16 a[36:39], a[172:175], v[60:63], a[36:39]
  s_waitcnt lgkmcnt(14)
  v_add_f32 v32, v32, v33
  v_add_f32 v36, v36, v37
  v_cmp_ngt_f32 vcc, 0.5, v32
  v_cmp_ngt_f32 s[50:51], 0.5, v36
  ds_read_b64_tr_b16 a[224:225], v19 offset:57344
  ds_read_b64_tr_b16 a[226:227], v19 offset:61440
  v_mfma_f32_16x16x32_bf16 a[8:11], a[176:179], v[48:51], a[8:11]
  s_or_b64 vcc, vcc, s[50:51]
  s_cbranch_scc1 L_slow0
L_slow0_ret:
  v_mfma_f32_16x16x32_bf16 a[8:11], a[180:183], v[52:55], a[8:11]
  v_rcp_f32 v32, v32
  v_rcp_f32 v36, v36
  v_mfma_f32_16x16x32_bf16 a[40:43], a[176:179], v[56:59], a[40:43]
  v_mov_b32 v33, v32
  v_mov_b32 v37, v36
  v_accvgpr_read_b32 v128, a228
  v_mfma_f32_16x16x32_bf16 a[40:43], a[180:183], v[60:63], a[40:43]
  v_accvgpr_read_b32 v129, a229
  v_accvgpr_read_b32 v130, a230
  v_accvgpr_read_b32 v131, a231
  v_mfma_f32_16x16x32_bf16 a[12:15], a[184:187], v[48:51], a[12:15]
  v_accvgpr_read_b32 v132, a232
  v_accvgpr_read_b32 v133, a233
  v_accvgpr_read_b32 v134, a234
  v_mfma_f32_16x16x32_bf16 a[12:15], a[188:191], v[52:55], a[12:15]
  v_accvgpr_read_b32 v135, a235
  v_exp_f32 v26, v80
  v_mfma_f32_16x16x32_bf16 a[44:47], a[184:187], v[56:59], a[44:47]
  v_exp_f32 v27, v81
  v_exp_f32 v28, v82
  v_mfma_f32_16x16x32_bf16 a[44:47], a[188:191], v[60:63], a[44:47]
  s_waitcnt lgkmcnt(0)
  v_cvt_pk_bf16_f32 v176, v26, v27
  v_exp_f32 v29, v83
  v_mfma_f32_16x16x32_bf16 a[16:19], a[196:199], v[48:51], a[16:19]
  ds_read_b128 a[128:131], v8 offset:8192
  v_exp_f32 v26, v84
  v_mfma_f32_16x16x32_bf16 a[16:19], a[200:203], v[52:55], a[16:19]
  ds_read_b128 a[132:135], v9 offset:8192
  v_cvt_pk_bf16_f32 v177, v28, v29
  v_exp_f32 v27, v85
  v_mfma_f32_16x16x32_bf16 a[48:51], a[196:199], v[56:59], a[48:51]
  ds_read_b128 a[136:139], v10 offset:8192
  v_exp_f32 v28, v86
  v_mfma_f32_16x16x32_bf16 a[48:51], a[200:203], v[60:63], a[48:51]
  ds_read_b128 a[140:143], v11 offset:8192
  v_cvt_pk_bf16_f32 v178, v26, v27
  v_exp_f32 v29, v87
  v_mfma_f32_16x16x32_bf16 a[20:23], a[204:207], v[48:51], a[20:23]
  ds_read_b128 a[144:147], v8 offset:12288
  v_exp_f32 v26, v88
  v_mfma_f32_16x16x32_bf16 a[20:23], a[208:211], v[52:55], a[20:23]
  ds_read_b128 a[148:151], v9 offset:12288
  v_cvt_pk_bf16_f32 v179, v28, v29
  v_mfma_f32_16x16x32_bf16 a[52:55], a[204:207], v[56:59], a[52:55]
  ds_read_b128 a[152:155], v10 offset:12288
  v_exp_f32 v27, v89
  v_mfma_f32_16x16x32_bf16 a[52:55], a[208:211], v[60:63], a[52:55]
  ds_read_b128 a[156:159], v11 offset:12288
  v_exp_f32 v28, v90
  v_mfma_f32_16x16x32_bf16 a[24:27], a[212:215], v[48:51], a[24:27]
  v_cvt_pk_bf16_f32 v184, v26, v27
  v_exp_f32 v29, v91
  v_mfma_f32_16x16x32_bf16 a[24:27], a[216:219], v[52:55], a[24:27]
  v_exp_f32 v26, v92
  v_mfma_f32_16x16x32_bf16 a[56:59], a[212:215], v[56:59], a[56:59]
  v_cvt_pk_bf16_f32 v185, v28, v29
  v_exp_f32 v27, v93
  v_mfma_f32_16x16x32_bf16 a[56:59], a[216:219], v[60:63], a[56:59]
  v_exp_f32 v28, v94
  v_mfma_f32_16x16x32_bf16 a[28:31], a[220:223], v[48:51], a[28:31]
  v_cvt_pk_bf16_f32 v186, v26, v27
  v_exp_f32 v29, v95
  v_mfma_f32_16x16x32_bf16 a[28:31], a[224:227], v[52:55], a[28:31]
  s_nop 0
  v_cvt_pk_bf16_f32 v187, v28, v29
  v_mfma_f32_16x16x32_bf16 a[60:63], a[220:223], v[56:59], a[60:63]
  v_mfma_f32_16x16x32_bf16 a[60:63], a[224:227], v[60:63], a[60:63]
  s_waitcnt lgkmcnt(0)
  v_mfma_f32_16x16x32_bf16 v[112:115], a[128:131], a[96:99], v[136:139]
  ds_read_b64_tr_b16 a[160:161], v12 offset:16384
  ds_read_b64_tr_b16 a[162:163], v12 offset:20480
  v_accvgpr_read_b32 v64, a0
  v_accvgpr_read_b32 v65, a1
  v_accvgpr_read_b32 v66, a2
  v_accvgpr_read_b32 v67, a3
  v_mul_f32 v64, v64, v32
  v_mfma_f32_16x16x32_bf16 v[112:115], a[132:135], a[100:103], v[112:115]
  ds_read_b64_tr_b16 a[164:165], v12 offset:24576
  v_mul_f32 v65, v65, v32
  v_mul_f32 v66, v66, v32
  v_mul_f32 v67, v67, v32
  v_cvt_pk_bf16_f32 v64, v64, v65
  v_cvt_pk_bf16_f32 v65, v66, v67
  v_mfma_f32_16x16x32_bf16 v[112:115], a[136:139], a[104:107], v[112:115]
  ds_read_b64_tr_b16 a[166:167], v12 offset:28672
  ds_write_b64 v128, v[64:65] offset:0
  v_accvgpr_read_b32 v68, a4
  v_accvgpr_read_b32 v69, a5
  v_accvgpr_read_b32 v70, a6
  v_accvgpr_read_b32 v71, a7
  v_mul_f32 v68, v68, v32
  v_mfma_f32_16x16x32_bf16 v[112:115], a[140:143], a[108:111], v[112:115]
  ds_read_b64_tr_b16 a[168:169], v13 offset:16384
  v_mul_f32 v69, v69, v32
  v_mul_f32 v70, v70, v32
  v_mul_f32 v71, v71, v32
  v_cvt_pk_bf16_f32 v68, v68, v69
  v_cvt_pk_bf16_f32 v69, v70, v71
  v_mfma_f32_16x16x32_bf16 v[120:123], a[128:131], a[112:115], v[140:143]
  ds_read_b64_tr_b16 a[170:171], v13 offset:20480
  ds_write_b64 v129, v[68:69] offset:0
  v_accvgpr_read_b32 v72, a8
  v_accvgpr_read_b32 v73, a9
  v_accvgpr_read_b32 v74, a10
  v_accvgpr_read_b32 v75, a11
  v_mul_f32 v72, v72, v32
  v_mfma_f32_16x16x32_bf16 v[120:123], a[132:135], a[116:119], v[120:123]
  ds_read_b64_tr_b16 a[172:173], v13 offset:24576
  v_mul_f32 v73, v73, v32
  v_mul_f32 v74, v74, v32
  v_mul_f32 v75, v75, v32
  v_cvt_pk_bf16_f32 v72, v72, v73
  v_cvt_pk_bf16_f32 v73, v74, v75
  v_mfma_f32_16x16x32_bf16 v[120:123], a[136:139], a[120:123], v[120:123]
  ds_read_b64_tr_b16 a[174:175], v13 offset:28672
  ds_write_b64 v130, v[72:73] offset:0
  v_accvgpr_read_b32 v76, a12
  v_accvgpr_read_b32 v77, a13
  v_accvgpr_read_b32 v78, a14
  v_accvgpr_read_b32 v79, a15
  v_mul_f32 v76, v76, v32
  v_mfma_f32_16x16x32_bf16 v[120:123], a[140:143], a[124:127], v[120:123]
  ds_read_b64_tr_b16 a[176:177], v14 offset:16384
  ds_read_b64_tr_b16 a[178:179], v14 offset:20480
  v_mul_f32 v77, v77, v32
  v_mul_f32 v78, v78, v32
  v_mul_f32 v79, v79, v32
  v_cvt_pk_bf16_f32 v76, v76, v77
  v_cvt_pk_bf16_f32 v77, v78, v79
  v_mfma_f32_16x16x32_bf16 v[116:119], a[144:147], a[96:99], v[136:139]
  ds_read_b64_tr_b16 a[180:181], v14 offset:24576
  ds_write_b64 v131, v[76:77] offset:0
  v_accvgpr_read_b32 v64, a16
  v_accvgpr_read_b32 v65, a17
  v_accvgpr_read_b32 v66, a18
  v_accvgpr_read_b32 v67, a19
  v_mul_f32 v64, v64, v32
  v_mfma_f32_16x16x32_bf16 v[116:119], a[148:151], a[100:103], v[116:119]
  ds_read_b64_tr_b16 a[182:183], v14 offset:28672
  v_mul_f32 v65, v65, v32
  v_mul_f32 v66, v66, v32
  v_mul_f32 v67, v67, v32
  v_cvt_pk_bf16_f32 v64, v64, v65
  v_cvt_pk_bf16_f32 v65, v66, v67
  v_mfma_f32_16x16x32_bf16 v[116:119], a[152:155], a[104:107], v[116:119]
  ds_read_b64_tr_b16 a[184:185], v15 offset:16384
  ds_write_b64 v132, v[64:65] offset:0
  v_accvgpr_read_b32 v68, a20
  v_accvgpr_read_b32 v69, a21
  v_accvgpr_read_b32 v70, a22
  v_accvgpr_read_b32 v71, a23
  v_mul_f32 v68, v68, v32
  v_mfma_f32_16x16x32_bf16 v[116:119], a[156:159], a[108:111], v[116:119]
  ds_read_b64_tr_b16 a[186:187], v15 offset:20480
  v_mul_f32 v69, v69, v32
  v_mul_f32 v70, v70, v32
  v_mul_f32 v71, v71, v32
  v_cvt_pk_bf16_f32 v68, v68, v69
  v_cvt_pk_bf16_f32 v69, v70, v71
  v_mfma_f32_16x16x32_bf16 v[124:127], a[144:147], a[112:115], v[140:143]
  ds_read_b64_tr_b16 a[188:189], v15 offset:24576
  ds_write_b64 v133, v[68:69] offset:0
  v_accvgpr_read_b32 v72, a24
  v_accvgpr_read_b32 v73, a25
  v_accvgpr_read_b32 v74, a26
  v_accvgpr_read_b32 v75, a27
  v_mul_f32 v72, v72, v32
  v_mfma_f32_16x16x32_bf16 v[124:127], a[148:151], a[116:119], v[124:127]
  ds_read_b64_tr_b16 a[190:191], v15 offset:28672
  v_mul_f32 v73, v73, v32
  v_mul_f32 v74, v74, v32
  v_mul_f32 v75, v75, v32
  v_cvt_pk_bf16_f32 v72, v72, v73
  v_cvt_pk_bf16_f32 v73, v74, v75
  v_mfma_f32_16x16x32_bf16 v[124:127], a[152:155], a[120:123], v[124:127]
  ds_write_b64 v134, v[72:73] offset:0
  v_accvgpr_read_b32 v76, a28
  v_accvgpr_read_b32 v77, a29
  v_accvgpr_read_b32 v78, a30
  v_accvgpr_read_b32 v79, a31
  v_mul_f32 v76, v76, v32
  v_mul_f32 v77, v77, v32
  v_mfma_f32_16x16x32_bf16 v[124:127], a[156:159], a[124:127], v[124:127]
  v_mul_f32 v78, v78, v32
  v_mul_f32 v79, v79, v32
  v_cvt_pk_bf16_f32 v76, v76, v77
  v_cvt_pk_bf16_f32 v77, v78, v79
  v_smfmac_f32_16x16x64_bf16 v[40:43], a[236:239], v[144:151], v1
  s_waitcnt lgkmcnt(13)
  ds_write_b64 v135, v[76:77] offset:0
  ds_read_b128 v[96:99], v4 offset:0
  ds_read_b128 v[100:103], v5 offset:1024
  ds_read_b128 v[104:107], v30 offset:2048
  ds_read_b128 v[108:111], v31 offset:3072
  v_accvgpr_read_b32 v64, a32
  v_accvgpr_read_b32 v65, a33
  v_mfma_f32_16x16x32_bf16 v[192:195], a[160:163], v[144:147], v[192:195]
  ds_read_b128 a[196:199], v8 offset:16384
  v_accvgpr_read_b32 v66, a34
  v_accvgpr_read_b32 v67, a35
  v_mul_f32 v64, v64, v36
  v_mul_f32 v65, v65, v36
  v_mul_f32 v66, v66, v36
  v_mul_f32 v67, v67, v36
  v_mfma_f32_16x16x32_bf16 v[192:195], a[164:167], v[148:151], v[192:195]
  ds_read_b128 a[200:203], v9 offset:16384
  v_cvt_pk_bf16_f32 v64, v64, v65
  v_cvt_pk_bf16_f32 v65, v66, v67
  v_mfma_f32_16x16x32_bf16 v[224:227], a[160:163], v[152:155], v[224:227]
  ds_read_b128 a[204:207], v10 offset:16384
  ds_write_b64 v128, v[64:65] offset:4096
  v_accvgpr_read_b32 v68, a36
  v_accvgpr_read_b32 v69, a37
  v_accvgpr_read_b32 v70, a38
  v_accvgpr_read_b32 v71, a39
  v_mul_f32 v68, v68, v36
  v_mfma_f32_16x16x32_bf16 v[224:227], a[164:167], v[156:159], v[224:227]
  v_mul_f32 v69, v69, v36
  v_mul_f32 v70, v70, v36
  v_mul_f32 v71, v71, v36
  v_cvt_pk_bf16_f32 v68, v68, v69
  v_cvt_pk_bf16_f32 v69, v70, v71
  v_mfma_f32_16x16x32_bf16 v[196:199], a[168:171], v[144:147], v[196:199]
  ds_read_b128 a[208:211], v11 offset:16384
  ds_write_b64 v129, v[68:69] offset:4096
  s_mov_b32 s33, s34
  s_waitcnt lgkmcnt(9)
  buffer_store_dwordx4 v[96:99], v0, s[28:31], s33 offen offset:0 nt sc1
  v_accvgpr_read_b32 v72, a40
  v_accvgpr_read_b32 v73, a41
  v_mfma_f32_16x16x32_bf16 v[196:199], a[172:175], v[148:151], v[196:199]
  ds_read_b128 a[212:215], v8 offset:20480
  v_accvgpr_read_b32 v74, a42
  v_accvgpr_read_b32 v75, a43
  v_mul_f32 v72, v72, v36
  v_mul_f32 v73, v73, v36
  v_mul_f32 v74, v74, v36
  v_mul_f32 v75, v75, v36
  v_mfma_f32_16x16x32_bf16 v[228:231], a[168:171], v[152:155], v[228:231]
  ds_read_b128 a[216:219], v9 offset:20480
  v_cvt_pk_bf16_f32 v72, v72, v73
  v_cvt_pk_bf16_f32 v73, v74, v75
  v_mfma_f32_16x16x32_bf16 v[228:231], a[172:175], v[156:159], v[228:231]
  s_waitcnt lgkmcnt(14)
  ds_write_b64 v130, v[72:73] offset:4096
  v_accvgpr_read_b32 v76, a44
  v_accvgpr_read_b32 v77, a45
  v_accvgpr_read_b32 v78, a46
  v_accvgpr_read_b32 v79, a47
  v_mul_f32 v76, v76, v36
  v_mul_f32 v77, v77, v36
  v_mul_f32 v78, v78, v36
  v_mfma_f32_16x16x32_bf16 v[200:203], a[176:179], v[144:147], v[200:203]
  ds_read_b128 a[220:223], v10 offset:20480
  v_mul_f32 v79, v79, v36
  v_cvt_pk_bf16_f32 v76, v76, v77
  v_cvt_pk_bf16_f32 v77, v78, v79
  v_mfma_f32_16x16x32_bf16 v[200:203], a[180:183], v[148:151], v[200:203]
  ds_read_b128 a[224:227], v11 offset:20480
  ds_write_b64 v131, v[76:77] offset:4096
  s_waitcnt lgkmcnt(14)
  buffer_store_dwordx4 v[100:103], v0, s[28:31], s33 offen offset:1024 nt sc1
  s_waitcnt lgkmcnt(13)
  buffer_store_dwordx4 v[104:107], v0, s[28:31], s33 offen offset:2048 nt sc1
  v_accvgpr_read_b32 v64, a48
  v_accvgpr_read_b32 v65, a49
  v_mfma_f32_16x16x32_bf16 v[232:235], a[176:179], v[152:155], v[232:235]
  v_accvgpr_read_b32 v66, a50
  v_accvgpr_read_b32 v67, a51
  v_mul_f32 v64, v64, v36
  v_mul_f32 v65, v65, v36
  v_mul_f32 v66, v66, v36
  v_mul_f32 v67, v67, v36
  v_cvt_pk_bf16_f32 v64, v64, v65
  v_cvt_pk_bf16_f32 v65, v66, v67
  v_mfma_f32_16x16x32_bf16 v[232:235], a[180:183], v[156:159], v[232:235]
  ds_write_b64 v132, v[64:65] offset:4096
  v_accvgpr_read_b32 v68, a52
  v_accvgpr_read_b32 v69, a53
  v_accvgpr_read_b32 v70, a54
  v_accvgpr_read_b32 v71, a55
  v_mul_f32 v68, v68, v36
  v_mul_f32 v69, v69, v36
  v_mul_f32 v70, v70, v36
  v_mfma_f32_16x16x32_bf16 v[204:207], a[184:187], v[144:147], v[204:207]
  v_mul_f32 v71, v71, v36
  v_cvt_pk_bf16_f32 v68, v68, v69
  v_cvt_pk_bf16_f32 v69, v70, v71
  v_mfma_f32_16x16x32_bf16 v[204:207], a[188:191], v[148:151], v[204:207]
  ds_write_b64 v133, v[68:69] offset:4096
  s_waitcnt lgkmcnt(14)
  buffer_store_dwordx4 v[108:111], v0, s[28:31], s33 offen offset:3072 nt sc1
  v_accvgpr_read_b32 v72, a56
  v_accvgpr_read_b32 v73, a57
  v_accvgpr_read_b32 v74, a58
  v_accvgpr_read_b32 v75, a59
  v_mul_f32 v72, v72, v36
  v_mul_f32 v73, v73, v36
  v_mul_f32 v74, v74, v36
  v_mfma_f32_16x16x32_bf16 v[236:239], a[184:187], v[152:155], v[236:239]
  v_mul_f32 v75, v75, v36
  v_cvt_pk_bf16_f32 v72, v72, v73
  v_cvt_pk_bf16_f32 v73, v74, v75
  v_mfma_f32_16x16x32_bf16 v[236:239], a[188:191], v[156:159], v[236:239]
  s_waitcnt lgkmcnt(9)
  ds_write_b64 v134, v[72:73] offset:4096
  v_accvgpr_read_b32 v76, a60
  v_accvgpr_read_b32 v77, a61
  v_accvgpr_read_b32 v78, a62
  v_accvgpr_read_b32 v79, a63
  v_mul_f32 v76, v76, v36
  v_mul_f32 v77, v77, v36
  v_mul_f32 v78, v78, v36
  v_mul_f32 v79, v79, v36
  v_cvt_pk_bf16_f32 v76, v76, v77
  v_cvt_pk_bf16_f32 v77, v78, v79
  ds_write_b64 v135, v[76:77] offset:4096
  ds_read_b128 v[160:163], v4 offset:4096
  ds_read_b128 v[164:167], v5 offset:5120
  ds_read_b128 v[168:171], v30 offset:6144
  ds_read_b128 v[172:175], v31 offset:7168
  v_mfma_f32_16x16x32_bf16 v[80:83], a[196:199], a[96:99], v[136:139]
  ds_read_b64_tr_b16 a[128:129], v16 offset:16384
  ds_read_b64_tr_b16 a[130:131], v16 offset:20480
  v_mfma_f32_16x16x32_bf16 v[80:83], a[200:203], a[100:103], v[80:83]
  v_exp_f32 v26, v112
  v_mfma_f32_16x16x32_bf16 v[80:83], a[204:207], a[104:107], v[80:83]
  ds_read_b64_tr_b16 a[132:133], v16 offset:24576
  ds_read_b64_tr_b16 a[134:135], v16 offset:28672
  v_mfma_f32_16x16x32_bf16 v[80:83], a[208:211], a[108:111], v[80:83]
  v_exp_f32 v27, v113
  v_mfma_f32_16x16x32_bf16 v[88:91], a[196:199], a[112:115], v[140:143]
L_isl5:
  s_cbranch_execz L_warm_done
  ds_read_b64_tr_b16 a[136:137], v17 offset:16384
  v_cvt_pk_bf16_f32 v180, v26, v27
  v_mfma_f32_16x16x32_bf16 v[88:91], a[200:203], a[116:119], v[88:91]
  v_exp_f32 v28, v114
  v_mfma_f32_16x16x32_bf16 v[88:91], a[204:207], a[120:123], v[88:91]
  ds_read_b64_tr_b16 a[138:139], v17 offset:20480
  ds_read_b64_tr_b16 a[140:141], v17 offset:24576
  v_mfma_f32_16x16x32_bf16 v[88:91], a[208:211], a[124:127], v[88:91]
  s_waitcnt lgkmcnt(15)
  v_exp_f32 v29, v115
  v_mfma_f32_16x16x32_bf16 v[84:87], a[212:215], a[96:99], v[136:139]
  ds_read_b64_tr_b16 a[142:143], v17 offset:28672
  v_cvt_pk_bf16_f32 v181, v28, v29
  v_mfma_f32_16x16x32_bf16 v[84:87], a[216:219], a[100:103], v[84:87]
  s_add_u32 s33, s34, 4096
  s_waitcnt lgkmcnt(11)
  buffer_store_dwordx4 v[160:163], v0, s[28:31], s33 offen offset:0 nt sc1
  v_exp_f32 v26, v116
  v_mfma_f32_16x16x32_bf16 v[84:87], a[220:223], a[104:107], v[84:87]
  ds_read_b64_tr_b16 a[144:145], v18 offset:16384
  ds_read_b64_tr_b16 a[146:147], v18 offset:20480
  v_mfma_f32_16x16x32_bf16 v[84:87], a[224:227], a[108:111], v[84:87]
  v_exp_f32 v27, v117
  v_mfma_f32_16x16x32_bf16 v[92:95], a[212:215], a[112:115], v[140:143]
  ds_read_b64_tr_b16 a[148:149], v18 offset:24576
  v_cvt_pk_bf16_f32 v182, v26, v27
  v_mfma_f32_16x16x32_bf16 v[92:95], a[216:219], a[116:119], v[92:95]
  s_waitcnt lgkmcnt(13)
  buffer_store_dwordx4 v[164:167], v0, s[28:31], s33 offen offset:1024 nt sc1
  v_exp_f32 v28, v118
  v_mfma_f32_16x16x32_bf16 v[92:95], a[220:223], a[120:123], v[92:95]
  ds_read_b64_tr_b16 a[150:151], v18 offset:28672
  ds_read_b64_tr_b16 a[152:153], v19 offset:16384
  v_mfma_f32_16x16x32_bf16 v[92:95], a[224:227], a[124:127], v[92:95]
  v_exp_f32 v29, v119
  v_smfmac_f32_16x16x64_bf16 v[44:47], a[236:239], v[152:159], v1
  s_waitcnt lgkmcnt(5)
  ds_read_b64_tr_b16 a[154:155], v19 offset:20480
  v_cvt_pk_bf16_f32 v183, v28, v29
  v_mfma_f32_16x16x32_bf16 v[208:211], a[128:131], v[144:147], v[208:211]
  s_waitcnt lgkmcnt(15)
  buffer_store_dwordx4 v[168:171], v0, s[28:31], s33 offen offset:2048 nt sc1
  v_exp_f32 v26, v120
  v_mfma_f32_16x16x32_bf16 v[208:211], a[132:135], v[148:151], v[208:211]
  ds_read_b64_tr_b16 a[156:157], v19 offset:24576
  ds_read_b64_tr_b16 a[158:159], v19 offset:28672
  v_mfma_f32_16x16x32_bf16 v[240:243], a[128:131], v[152:155], v[240:243]
  v_exp_f32 v27, v121
  v_mfma_f32_16x16x32_bf16 v[240:243], a[132:135], v[156:159], v[240:243]
  ds_read_b128 a[160:163], v8 offset:24576
  v_cvt_pk_bf16_f32 v188, v26, v27
  v_mfma_f32_16x16x32_bf16 v[212:215], a[136:139], v[144:147], v[212:215]
  s_waitcnt lgkmcnt(15)
  buffer_store_dwordx4 v[172:175], v0, s[28:31], s33 offen offset:3072 nt sc1
  v_exp_f32 v28, v122
  v_mfma_f32_16x16x32_bf16 v[212:215], a[140:143], v[148:151], v[212:215]
  ds_read_b128 a[164:167], v9 offset:24576
  ds_read_b128 a[168:171], v10 offset:24576
  v_mfma_f32_16x16x32_bf16 v[244:247], a[136:139], v[152:155], v[244:247]
  v_exp_f32 v29, v123
  v_mfma_f32_16x16x32_bf16 v[244:247], a[140:143], v[156:159], v[244:247]
  s_waitcnt lgkmcnt(3)
  ds_read_b128 a[172:175], v11 offset:24576
  v_cvt_pk_bf16_f32 v189, v28, v29
  v_mfma_f32_16x16x32_bf16 v[216:219], a[144:147], v[144:147], v[216:219]
  v_exp_f32 v26, v124
  v_mfma_f32_16x16x32_bf16 v[216:219], a[148:151], v[148:151], v[216:219]
  ds_read_b128 a[176:179], v8 offset:28672
  ds_read_b128 a[180:183], v9 offset:28672
  v_mfma_f32_16x16x32_bf16 v[248:251], a[144:147], v[152:155], v[248:251]
  v_exp_f32 v27, v125
  v_mfma_f32_16x16x32_bf16 v[248:251], a[148:151], v[156:159], v[248:251]
  ds_read_b128 a[184:187], v10 offset:28672
  v_cvt_pk_bf16_f32 v190, v26, v27
  v_mfma_f32_16x16x32_bf16 v[220:223], a[152:155], v[144:147], v[220:223]
  v_exp_f32 v28, v126
  v_mfma_f32_16x16x32_bf16 v[220:223], a[156:159], v[148:151], v[220:223]
  ds_read_b128 a[188:191], v11 offset:28672
  v_mfma_f32_16x16x32_bf16 v[252:255], a[152:155], v[152:155], v[252:255]
  v_exp_f32 v29, v127
  v_mfma_f32_16x16x32_bf16 v[252:255], a[156:159], v[156:159], v[252:255]
  s_waitcnt lgkmcnt(4)
  v_cvt_pk_bf16_f32 v191, v28, v29
  v_mfma_f32_16x16x32_bf16 v[112:115], a[160:163], a[96:99], v[136:139]
  ds_read_b64_tr_b16 a[196:197], v12 offset:32768
  ds_read_b64_tr_b16 a[198:199], v12 offset:36864
  ds_read_b64_tr_b16 a[200:201], v12 offset:40960
  v_mfma_f32_16x16x32_bf16 v[112:115], a[164:167], a[100:103], v[112:115]
  v_exp_f32 v26, v80
  v_mfma_f32_16x16x32_bf16 v[112:115], a[168:171], a[104:107], v[112:115]
  ds_read_b64_tr_b16 a[202:203], v12 offset:45056
  ds_read_b64_tr_b16 a[204:205], v13 offset:32768
  ds_read_b64_tr_b16 a[206:207], v13 offset:36864
  v_mfma_f32_16x16x32_bf16 v[112:115], a[172:175], a[108:111], v[112:115]
  v_exp_f32 v27, v81
  v_mfma_f32_16x16x32_bf16 v[120:123], a[160:163], a[112:115], v[140:143]
  ds_read_b64_tr_b16 a[208:209], v13 offset:40960
  ds_read_b64_tr_b16 a[210:211], v13 offset:45056
  v_cvt_pk_bf16_f32 v144, v26, v27
  v_mfma_f32_16x16x32_bf16 v[120:123], a[164:167], a[116:119], v[120:123]
  v_exp_f32 v28, v82
  v_mfma_f32_16x16x32_bf16 v[120:123], a[168:171], a[120:123], v[120:123]
  ds_read_b64_tr_b16 a[212:213], v14 offset:32768
  ds_read_b64_tr_b16 a[214:215], v14 offset:36864
  v_mfma_f32_16x16x32_bf16 v[120:123], a[172:175], a[124:127], v[120:123]
  s_waitcnt lgkmcnt(10)
  v_exp_f32 v29, v83
  v_mfma_f32_16x16x32_bf16 v[116:119], a[176:179], a[96:99], v[136:139]
  ds_read_b64_tr_b16 a[216:217], v14 offset:40960
  v_cvt_pk_bf16_f32 v145, v28, v29
  v_mfma_f32_16x16x32_bf16 v[116:119], a[180:183], a[100:103], v[116:119]
  v_exp_f32 v26, v84
  v_mfma_f32_16x16x32_bf16 v[116:119], a[184:187], a[104:107], v[116:119]
  ds_read_b64_tr_b16 a[218:219], v14 offset:45056
  ds_read_b64_tr_b16 a[220:221], v15 offset:32768
  v_mfma_f32_16x16x32_bf16 v[116:119], a[188:191], a[108:111], v[116:119]
  v_exp_f32 v27, v85
  v_mfma_f32_16x16x32_bf16 v[124:127], a[176:179], a[112:115], v[140:143]
  ds_read_b64_tr_b16 a[222:223], v15 offset:36864
  v_cvt_pk_bf16_f32 v146, v26, v27
  v_mfma_f32_16x16x32_bf16 v[124:127], a[180:183], a[116:119], v[124:127]
  v_exp_f32 v28, v86
  v_mfma_f32_16x16x32_bf16 v[124:127], a[184:187], a[120:123], v[124:127]
  ds_read_b64_tr_b16 a[224:225], v15 offset:40960
  ds_read_b64_tr_b16 a[226:227], v15 offset:45056
  v_mfma_f32_16x16x32_bf16 v[124:127], a[188:191], a[124:127], v[124:127]
  v_exp_f32 v29, v87
  v_smfmac_f32_16x16x64_bf16 v[40:43], a[236:239], v[176:183], v1
  s_waitcnt lgkmcnt(8)
  v_cvt_pk_bf16_f32 v147, v28, v29
  v_mfma_f32_16x16x32_bf16 v[192:195], a[196:199], v[176:179], v[192:195]
  v_exp_f32 v26, v88
  v_mfma_f32_16x16x32_bf16 v[192:195], a[200:203], v[180:183], v[192:195]
  ds_read_b64_tr_b16 a[128:129], v16 offset:32768
  ds_read_b64_tr_b16 a[130:131], v16 offset:36864
  ds_read_b64_tr_b16 a[132:133], v16 offset:40960
  v_mfma_f32_16x16x32_bf16 v[224:227], a[196:199], v[184:187], v[224:227]
  v_exp_f32 v27, v89
  v_mfma_f32_16x16x32_bf16 v[224:227], a[200:203], v[188:191], v[224:227]
  ds_read_b64_tr_b16 a[134:135], v16 offset:45056
  ds_read_b64_tr_b16 a[136:137], v17 offset:32768
  v_cvt_pk_bf16_f32 v152, v26, v27
  v_mfma_f32_16x16x32_bf16 v[196:199], a[204:207], v[176:179], v[196:199]
  v_exp_f32 v28, v90
  v_mfma_f32_16x16x32_bf16 v[196:199], a[208:211], v[180:183], v[196:199]
  ds_read_b64_tr_b16 a[138:139], v17 offset:36864
  ds_read_b64_tr_b16 a[140:141], v17 offset:40960
  ds_read_b64_tr_b16 a[142:143], v17 offset:45056
  v_mfma_f32_16x16x32_bf16 v[228:231], a[204:207], v[184:187], v[228:231]
  v_exp_f32 v29, v91
  v_mfma_f32_16x16x32_bf16 v[228:231], a[208:211], v[188:191], v[228:231]
  s_waitcnt lgkmcnt(8)
  ds_read_b64_tr_b16 a[144:145], v18 offset:32768
  ds_read_b64_tr_b16 a[146:147], v18 offset:36864
  v_cvt_pk_bf16_f32 v153, v28, v29
  v_mfma_f32_16x16x32_bf16 v[200:203], a[212:215], v[176:179], v[200:203]
  v_exp_f32 v26, v92
  v_mfma_f32_16x16x32_bf16 v[200:203], a[216:219], v[180:183], v[200:203]
  ds_read_b64_tr_b16 a[148:149], v18 offset:40960
  ds_read_b64_tr_b16 a[150:151], v18 offset:45056
  ds_read_b64_tr_b16 a[152:153], v19 offset:32768
  v_mfma_f32_16x16x32_bf16 v[232:235], a[212:215], v[184:187], v[232:235]
  v_exp_f32 v27, v93
  v_mfma_f32_16x16x32_bf16 v[232:235], a[216:219], v[188:191], v[232:235]
  ds_read_b64_tr_b16 a[154:155], v19 offset:36864
  v_cvt_pk_bf16_f32 v154, v26, v27
  v_mfma_f32_16x16x32_bf16 v[204:207], a[220:223], v[176:179], v[204:207]
  v_exp_f32 v28, v94
  v_mfma_f32_16x16x32_bf16 v[204:207], a[224:227], v[180:183], v[204:207]
  ds_read_b64_tr_b16 a[156:157], v19 offset:40960
  ds_read_b64_tr_b16 a[158:159], v19 offset:45056
  v_mfma_f32_16x16x32_bf16 v[236:239], a[220:223], v[184:187], v[236:239]
  v_exp_f32 v29, v95
  v_mfma_f32_16x16x32_bf16 v[236:239], a[224:227], v[188:191], v[236:239]
  s_waitcnt lgkmcnt(8)
  v_cvt_pk_bf16_f32 v155, v28, v29
  v_smfmac_f32_16x16x64_bf16 v[44:47], a[236:239], v[184:191], v1
  ds_read_b64_tr_b16 a[160:161], v12 offset:49152
  v_exp_f32 v26, v112
  v_mfma_f32_16x16x32_bf16 v[208:211], a[128:131], v[176:179], v[208:211]
  ds_read_b64_tr_b16 a[162:163], v12 offset:53248
  v_exp_f32 v27, v113
  v_mfma_f32_16x16x32_bf16 v[208:211], a[132:135], v[180:183], v[208:211]
  v_cvt_pk_bf16_f32 v148, v26, v27
  v_exp_f32 v28, v114
  v_mfma_f32_16x16x32_bf16 v[240:243], a[128:131], v[184:187], v[240:243]
  ds_read_b64_tr_b16 a[164:165], v12 offset:57344
  v_exp_f32 v29, v115
  v_mfma_f32_16x16x32_bf16 v[240:243], a[132:135], v[188:191], v[240:243]
  v_cvt_pk_bf16_f32 v149, v28, v29
  v_exp_f32 v26, v116
  v_mfma_f32_16x16x32_bf16 v[212:215], a[136:139], v[176:179], v[212:215]
  ds_read_b64_tr_b16 a[166:167], v12 offset:61440
  v_exp_f32 v27, v117
  v_mfma_f32_16x16x32_bf16 v[212:215], a[140:143], v[180:183], v[212:215]
  v_cvt_pk_bf16_f32 v150, v26, v27
  v_exp_f32 v28, v118
  v_mfma_f32_16x16x32_bf16 v[244:247], a[136:139], v[184:187], v[244:247]
  ds_read_b64_tr_b16 a[168:169], v13 offset:49152
  v_exp_f32 v29, v119
  v_mfma_f32_16x16x32_bf16 v[244:247], a[140:143], v[188:191], v[244:247]
  s_waitcnt lgkmcnt(5)
  v_cvt_pk_bf16_f32 v151, v28, v29
  v_exp_f32 v26, v120
  v_mfma_f32_16x16x32_bf16 v[216:219], a[144:147], v[176:179], v[216:219]
  ds_read_b64_tr_b16 a[170:171], v13 offset:53248
  v_exp_f32 v27, v121
  v_mfma_f32_16x16x32_bf16 v[216:219], a[148:151], v[180:183], v[216:219]
  v_cvt_pk_bf16_f32 v156, v26, v27
  v_exp_f32 v28, v122
  v_mfma_f32_16x16x32_bf16 v[248:251], a[144:147], v[184:187], v[248:251]
  ds_read_b64_tr_b16 a[172:173], v13 offset:57344
  v_exp_f32 v29, v123
  v_mfma_f32_16x16x32_bf16 v[248:251], a[148:151], v[188:191], v[248:251]
  v_cvt_pk_bf16_f32 v157, v28, v29
  v_exp_f32 v26, v124
  v_mfma_f32_16x16x32_bf16 v[220:223], a[152:155], v[176:179], v[220:223]
  v_exp_f32 v27, v125
  v_mfma_f32_16x16x32_bf16 v[220:223], a[156:159], v[180:183], v[220:223]
  v_cvt_pk_bf16_f32 v158, v26, v27
  v_exp_f32 v28, v126
  v_mfma_f32_16x16x32_bf16 v[252:255], a[152:155], v[184:187], v[252:255]
  v_exp_f32 v29, v127
  v_mfma_f32_16x16x32_bf16 v[252:255], a[156:159], v[188:191], v[252:255]
  ds_read_b64_tr_b16 a[174:175], v13 offset:61440
  v_cvt_pk_bf16_f32 v159, v28, v29
  s_nop 1
  v_smfmac_f32_16x16x64_bf16 v[40:43], a[236:239], v[144:151], v1
  ds_read_b64_tr_b16 a[176:177], v14 offset:49152
  ds_read_b64_tr_b16 a[178:179], v14 offset:53248
  ds_read_b64_tr_b16 a[180:181], v14 offset:57344
  v_smfmac_f32_16x16x64_bf16 v[44:47], a[236:239], v[152:159], v1
  s_waitcnt lgkmcnt(3)
  ds_read_b64_tr_b16 a[182:183], v14 offset:61440
  ds_read_b64_tr_b16 a[184:185], v15 offset:49152
  ds_read_b64_tr_b16 a[186:187], v15 offset:53248
  v_mfma_f32_16x16x32_bf16 v[192:195], a[160:163], v[144:147], v[192:195]
  ds_read_b64_tr_b16 a[188:189], v15 offset:57344
  ds_read_b64_tr_b16 a[190:191], v15 offset:61440
  ds_read_b64_tr_b16 a[196:197], v16 offset:49152
  v_mfma_f32_16x16x32_bf16 v[192:195], a[164:167], v[148:151], v[192:195]
  ds_read_b64_tr_b16 a[198:199], v16 offset:53248
  ds_read_b64_tr_b16 a[200:201], v16 offset:57344
  ds_read_b64_tr_b16 a[202:203], v16 offset:61440
  v_mfma_f32_16x16x32_bf16 v[196:199], a[168:171], v[144:147], v[196:199]
  ds_read_b64_tr_b16 a[204:205], v17 offset:49152
  ds_read_b64_tr_b16 a[206:207], v17 offset:53248
  ds_read_b64_tr_b16 a[208:209], v17 offset:57344
  v_mfma_f32_16x16x32_bf16 v[196:199], a[172:175], v[148:151], v[196:199]
  s_waitcnt lgkmcnt(7)
  ds_read_b64_tr_b16 a[210:211], v17 offset:61440
  ds_read_b64_tr_b16 a[212:213], v18 offset:49152
  ds_read_b64_tr_b16 a[214:215], v18 offset:53248
  v_mfma_f32_16x16x32_bf16 v[200:203], a[176:179], v[144:147], v[200:203]
  ds_read_b64_tr_b16 a[216:217], v18 offset:57344
  ds_read_b64_tr_b16 a[218:219], v18 offset:61440
  ds_read_b64_tr_b16 a[220:221], v19 offset:49152
  v_mfma_f32_16x16x32_bf16 v[200:203], a[180:183], v[148:151], v[200:203]
  ds_read_b64_tr_b16 a[222:223], v19 offset:53248
  ds_read_b64_tr_b16 a[224:225], v19 offset:57344
  ds_read_b64_tr_b16 a[226:227], v19 offset:61440
  v_mfma_f32_16x16x32_bf16 v[204:207], a[184:187], v[144:147], v[204:207]
  v_mfma_f32_16x16x32_bf16 v[204:207], a[188:191], v[148:151], v[204:207]
  s_waitcnt lgkmcnt(8)
  v_add_f32 v40, v40, v41
  v_add_f32 v44, v44, v45
  v_cmp_ngt_f32 vcc, 0.5, v40
  v_cmp_ngt_f32 s[50:51], 0.5, v44
  v_mfma_f32_16x16x32_bf16 v[208:211], a[196:199], v[144:147], v[208:211]
  s_or_b64 vcc, vcc, s[50:51]
  s_cbranch_scc1 L_slow2
L_slow2_ret:
  v_mfma_f32_16x16x32_bf16 v[208:211], a[200:203], v[148:151], v[208:211]
  v_rcp_f32 v40, v40
  v_rcp_f32 v44, v44
  v_mov_b32 v41, v40
  v_mfma_f32_16x16x32_bf16 v[212:215], a[204:207], v[144:147], v[212:215]
  v_mov_b32 v45, v44
  s_nop 3
  v_mul_f32 v192, v192, v40
  v_mul_f32 v193, v193, v40
  v_mul_f32 v194, v194, v40
  v_mfma_f32_16x16x32_bf16 v[212:215], a[208:211], v[148:151], v[212:215]
  s_waitcnt lgkmcnt(0)
  v_mul_f32 v195, v195, v40
  v_cvt_pk_bf16_f32 v192, v192, v193
  v_cvt_pk_bf16_f32 v193, v194, v195
  v_mfma_f32_16x16x32_bf16 v[216:219], a[212:215], v[144:147], v[216:219]
  ds_write_b64 v128, v[192:193] offset:8192
  v_mul_f32 v196, v196, v40
  v_mul_f32 v197, v197, v40
  v_mul_f32 v198, v198, v40
  v_mul_f32 v199, v199, v40
  v_mfma_f32_16x16x32_bf16 v[216:219], a[216:219], v[148:151], v[216:219]
  v_cvt_pk_bf16_f32 v196, v196, v197
  v_cvt_pk_bf16_f32 v197, v198, v199
  v_mfma_f32_16x16x32_bf16 v[220:223], a[220:223], v[144:147], v[220:223]
  ds_write_b64 v129, v[196:197] offset:8192
  v_mul_f32 v200, v200, v40
  v_mul_f32 v201, v201, v40
  v_mul_f32 v202, v202, v40
  v_mfma_f32_16x16x32_bf16 v[220:223], a[224:227], v[148:151], v[220:223]
  v_mul_f32 v203, v203, v40
  v_cvt_pk_bf16_f32 v200, v200, v201
  v_cvt_pk_bf16_f32 v201, v202, v203
  v_mfma_f32_16x16x32_bf16 v[224:227], a[160:163], v[152:155], v[224:227]
  ds_write_b64 v130, v[200:201] offset:8192
  v_mul_f32 v204, v204, v40
  v_mul_f32 v205, v205, v40
  v_mul_f32 v206, v206, v40
  v_mfma_f32_16x16x32_bf16 v[224:227], a[164:167], v[156:159], v[224:227]
  v_mul_f32 v207, v207, v40
  v_cvt_pk_bf16_f32 v204, v204, v205
  v_cvt_pk_bf16_f32 v205, v206, v207
  v_mfma_f32_16x16x32_bf16 v[228:231], a[168:171], v[152:155], v[228:231]
  ds_write_b64 v131, v[204:205] offset:8192
  v_mul_f32 v208, v208, v40
  v_mul_f32 v209, v209, v40
  v_mul_f32 v210, v210, v40
  v_mfma_f32_16x16x32_bf16 v[228:231], a[172:175], v[156:159], v[228:231]
  v_mul_f32 v211, v211, v40
  v_cvt_pk_bf16_f32 v208, v208, v209
  v_cvt_pk_bf16_f32 v209, v210, v211
  v_mfma_f32_16x16x32_bf16 v[232:235], a[176:179], v[152:155], v[232:235]
  ds_write_b64 v132, v[208:209] offset:8192
  v_mul_f32 v212, v212, v40
  v_mul_f32 v213, v213, v40
  v_mul_f32 v214, v214, v40
  v_mfma_f32_16x16x32_bf16 v[232:235], a[180:183], v[156:159], v[232:235]
  v_mul_f32 v215, v215, v40
  v_cvt_pk_bf16_f32 v212, v212, v213
  v_cvt_pk_bf16_f32 v213, v214, v215
  v_mfma_f32_16x16x32_bf16 v[236:239], a[184:187], v[152:155], v[236:239]
  ds_write_b64 v133, v[212:213] offset:8192
  v_mul_f32 v216, v216, v40
  v_mul_f32 v217, v217, v40
  v_mul_f32 v218, v218, v40
  v_mfma_f32_16x16x32_bf16 v[236:239], a[188:191], v[156:159], v[236:239]
  v_mul_f32 v219, v219, v40
  v_cvt_pk_bf16_f32 v216, v216, v217
  v_cvt_pk_bf16_f32 v217, v218, v219
  v_mfma_f32_16x16x32_bf16 v[240:243], a[196:199], v[152:155], v[240:243]
  ds_write_b64 v134, v[216:217] offset:8192
  v_mul_f32 v220, v220, v40
  v_mul_f32 v221, v221, v40
  v_mul_f32 v222, v222, v40
  v_mfma_f32_16x16x32_bf16 v[240:243], a[200:203], v[156:159], v[240:243]
  v_mul_f32 v223, v223, v40
  v_cvt_pk_bf16_f32 v220, v220, v221
  v_cvt_pk_bf16_f32 v221, v222, v223
  v_mfma_f32_16x16x32_bf16 v[244:247], a[204:207], v[152:155], v[244:247]
  ds_write_b64 v135, v[220:221] offset:8192
  ds_read_b128 v[64:67], v4 offset:8192
  ds_read_b128 v[68:71], v5 offset:9216
  ds_read_b128 v[72:75], v30 offset:10240
  ds_read_b128 v[76:79], v31 offset:11264
  v_mfma_f32_16x16x32_bf16 v[244:247], a[208:211], v[156:159], v[244:247]
  v_mul_f32 v224, v224, v44
  v_mul_f32 v225, v225, v44
  v_mul_f32 v226, v226, v44
  v_mul_f32 v227, v227, v44
  v_mfma_f32_16x16x32_bf16 v[248:251], a[212:215], v[152:155], v[248:251]
  v_cvt_pk_bf16_f32 v224, v224, v225
  v_cvt_pk_bf16_f32 v225, v226, v227
  v_mul_f32 v228, v228, v44
  v_mfma_f32_16x16x32_bf16 v[248:251], a[216:219], v[156:159], v[248:251]
  v_mul_f32 v229, v229, v44
  v_mul_f32 v230, v230, v44
  v_mul_f32 v231, v231, v44
  v_mfma_f32_16x16x32_bf16 v[252:255], a[220:223], v[152:155], v[252:255]
  v_cvt_pk_bf16_f32 v228, v228, v229
  v_cvt_pk_bf16_f32 v229, v230, v231
  v_mfma_f32_16x16x32_bf16 v[252:255], a[224:227], v[156:159], v[252:255]
  ds_write_b64 v128, v[224:225] offset:12288
  ds_write_b64 v129, v[228:229] offset:12288
  s_add_u32 s33, s34, 8192
  s_waitcnt lgkmcnt(5)
  buffer_store_dwordx4 v[64:67], v0, s[28:31], s33 offen offset:0 nt sc1
  v_mul_f32 v232, v232, v44
  v_mul_f32 v233, v233, v44
  v_mul_f32 v234, v234, v44
  v_mul_f32 v235, v235, v44
  v_cvt_pk_bf16_f32 v232, v232, v233
  v_cvt_pk_bf16_f32 v233, v234, v235
  v_mul_f32 v236, v236, v44
  v_mul_f32 v237, v237, v44
  v_mul_f32 v238, v238, v44
  v_mul_f32 v239, v239, v44
  v_cvt_pk_bf16_f32 v236, v236, v237
  v_cvt_pk_bf16_f32 v237, v238, v239
  ds_write_b64 v130, v[232:233] offset:12288
  ds_write_b64 v131, v[236:237] offset:12288
  s_waitcnt lgkmcnt(6)
  buffer_store_dwordx4 v[68:71], v0, s[28:31], s33 offen offset:1024 nt sc1
  s_waitcnt lgkmcnt(5)
  buffer_store_dwordx4 v[72:75], v0, s[28:31], s33 offen offset:2048 nt sc1
  v_mul_f32 v240, v240, v44
  v_mul_f32 v241, v241, v44
  v_mul_f32 v242, v242, v44
  v_mul_f32 v243, v243, v44
  v_cvt_pk_bf16_f32 v240, v240, v241
  v_cvt_pk_bf16_f32 v241, v242, v243
  v_mul_f32 v244, v244, v44
  v_mul_f32 v245, v245, v44
  v_mul_f32 v246, v246, v44
  v_mul_f32 v247, v247, v44
  v_cvt_pk_bf16_f32 v244, v244, v245
  v_cvt_pk_bf16_f32 v245, v246, v247
  ds_write_b64 v132, v[240:241] offset:12288
  ds_write_b64 v133, v[244:245] offset:12288
  s_waitcnt lgkmcnt(6)
  buffer_store_dwordx4 v[76:79], v0, s[28:31], s33 offen offset:3072 nt sc1
  v_mul_f32 v248, v248, v44
  v_mul_f32 v249, v249, v44
  v_mul_f32 v250, v250, v44
  v_mul_f32 v251, v251, v44
  v_cvt_pk_bf16_f32 v248, v248, v249
  v_cvt_pk_bf16_f32 v249, v250, v251
  v_mul_f32 v252, v252, v44
  v_mul_f32 v253, v253, v44
  v_mul_f32 v254, v254, v44
  v_mul_f32 v255, v255, v44
  v_cvt_pk_bf16_f32 v252, v252, v253
  v_cvt_pk_bf16_f32 v253, v254, v255
  ds_write_b64 v134, v[248:249] offset:12288
  ds_write_b64 v135, v[252:253] offset:12288
  ds_read_b128 v[80:83], v4 offset:12288
  ds_read_b128 v[84:87], v5 offset:13312
  ds_read_b128 v[88:91], v30 offset:14336
  ds_read_b128 v[92:95], v31 offset:15360
  s_add_u32 s33, s34, 12288
  s_waitcnt lgkmcnt(3)
  buffer_store_dwordx4 v[80:83], v0, s[28:31], s33 offen offset:0 nt sc1
  s_waitcnt lgkmcnt(2)
  buffer_store_dwordx4 v[84:87], v0, s[28:31], s33 offen offset:1024 nt sc1
  s_waitcnt lgkmcnt(1)
  buffer_store_dwordx4 v[88:91], v0, s[28:31], s33 offen offset:2048 nt sc1
  s_waitcnt lgkmcnt(0)
  buffer_store_dwordx4 v[92:95], v0, s[28:31], s33 offen offset:3072 nt sc1
L_end:
  s_endpgm
L_slow0:
  s_nop 15
  s_waitcnt vmcnt(0) lgkmcnt(0)
  v_accvgpr_write_b32 a0, 0
  v_accvgpr_write_b32 a1, 0
  v_accvgpr_write_b32 a2, 0
  v_accvgpr_write_b32 a3, 0
  v_accvgpr_write_b32 a4, 0
  v_accvgpr_write_b32 a5, 0
  v_accvgpr_write_b32 a6, 0
  v_accvgpr_write_b32 a7, 0
  v_accvgpr_write_b32 a8, 0
  v_accvgpr_write_b32 a9, 0
  v_accvgpr_write_b32 a10, 0
  v_accvgpr_write_b32 a11, 0
  v_accvgpr_write_b32 a12, 0
  v_accvgpr_write_b32 a13, 0
  v_accvgpr_write_b32 a14, 0
  v_accvgpr_write_b32 a15, 0
  v_accvgpr_write_b32 a16, 0
  v_accvgpr_write_b32 a17, 0
  v_accvgpr_write_b32 a18, 0
  v_accvgpr_write_b32 a19, 0
  v_accvgpr_write_b32 a20, 0
  v_accvgpr_write_b32 a21, 0
  v_accvgpr_write_b32 a22, 0
  v_accvgpr_write_b32 a23, 0
  v_accvgpr_write_b32 a24, 0
  v_accvgpr_write_b32 a25, 0
  v_accvgpr_write_b32 a26, 0
  v_accvgpr_write_b32 a27, 0
  v_accvgpr_write_b32 a28, 0
  v_accvgpr_write_b32 a29, 0
  v_accvgpr_write_b32 a30, 0
  v_accvgpr_write_b32 a31, 0
  v_mov_b32 v32, 0
  v_mov_b32 v33, 0
  v_mov_b32 v34, 0
  v_mov_b32 v35, 0
  v_mov_b32 v48, 0xff800000
  v_accvgpr_write_b32 a32, 0
  v_accvgpr_write_b32 a33, 0
  v_accvgpr_write_b32 a34, 0
  v_accvgpr_write_b32 a35, 0
  v_accvgpr_write_b32 a36, 0
  v_accvgpr_write_b32 a37, 0
  v_accvgpr_write_b32 a38, 0
  v_accvgpr_write_b32 a39, 0
  v_accvgpr_write_b32 a40, 0
  v_accvgpr_write_b32 a41, 0
  v_accvgpr_write_b32 a42, 0
  v_accvgpr_write_b32 a43, 0
  v_accvgpr_write_b32 a44, 0
  v_accvgpr_write_b32 a45, 0
  v_accvgpr_write_b32 a46, 0
  v_accvgpr_write_b32 a47, 0
  v_accvgpr_write_b32 a48, 0
  v_accvgpr_write_b32 a49, 0
  v_accvgpr_write_b32 a50, 0
  v_accvgpr_write_b32 a51, 0
  v_accvgpr_write_b32 a52, 0
  v_accvgpr_write_b32 a53, 0
  v_accvgpr_write_b32 a54, 0
  v_accvgpr_write_b32 a55, 0
  v_accvgpr_write_b32 a56, 0
  v_accvgpr_write_b32 a57, 0
  v_accvgpr_write_b32 a58, 0
  v_accvgpr_write_b32 a59, 0
  v_accvgpr_write_b32 a60, 0
  v_accvgpr_write_b32 a61, 0
  v_accvgpr_write_b32 a62, 0
  v_accvgpr_write_b32 a63, 0
  v_mov_b32 v36, 0
  v_mov_b32 v37, 0
  v_mov_b32 v38, 0
  v_mov_b32 v39, 0
  v_mov_b32 v49, 0xff800000
  s_sub_u32 s50, s47, 32768
  v_add_u32 v96, s50, v8
  v_add_u32 v97, s50, v9
  v_add_u32 v98, s50, v10
  v_add_u32 v99, s50, v11
  s_sub_u32 s50, s47, 57344
  v_add_u32 v100, s50, v12
  v_add_u32 v101, s50, v13
  v_add_u32 v102, s50, v14
  v_add_u32 v103, s50, v15
  v_add_u32 v104, s50, v16
  v_add_u32 v105, s50, v17
  v_add_u32 v106, s50, v18
  v_add_u32 v107, s50, v19
  s_mov_b32 s50, 0
L_slow0_loop:
  s_mov_b32 m0, s47
  s_mov_b32 s51, s50
  buffer_load_dwordx4 v20, s[20:23], s51 offen offset:0 lds
  buffer_load_dwordx4 v21, s[20:23], s51 offen offset:1024 lds
  buffer_load_dwordx4 v22, s[20:23], s51 offen offset:2048 lds
  buffer_load_dwordx4 v23, s[20:23], s51 offen offset:3072 lds
  s_add_u32 m0, s47, 4096
  s_add_u32 s51, s50, 4096
  buffer_load_dwordx4 v20, s[20:23], s51 offen offset:0 lds
  buffer_load_dwordx4 v21, s[20:23], s51 offen offset:1024 lds
  buffer_load_dwordx4 v22, s[20:23], s51 offen offset:2048 lds
  buffer_load_dwordx4 v23, s[20:23], s51 offen offset:3072 lds
  s_add_u32 m0, s47, 8192
  s_mov_b32 s51, s50
  buffer_load_dwordx4 v24, s[24:27], s51 offen offset:0 lds
  buffer_load_dwordx4 v25, s[24:27], s51 offen offset:1024 lds
  buffer_load_dwordx4 v24, s[24:27], s51 offen offset:2048 lds
  buffer_load_dwordx4 v25, s[24:27], s51 offen offset:3072 lds
  s_add_u32 m0, s47, 12288
  s_add_u32 s51, s50, 4096
  buffer_load_dwordx4 v24, s[24:27], s51 offen offset:0 lds
  buffer_load_dwordx4 v25, s[24:27], s51 offen offset:1024 lds
  buffer_load_dwordx4 v24, s[24:27], s51 offen offset:2048 lds
  buffer_load_dwordx4 v25, s[24:27], s51 offen offset:3072 lds
  s_waitcnt vmcnt(0)
  ds_read_b128 a[128:131], v96 offset:0
  ds_read_b128 a[132:135], v97 offset:0
  ds_read_b128 a[136:139], v98 offset:0
  ds_read_b128 a[140:143], v99 offset:0
  ds_read_b128 a[144:147], v96 offset:4096
  ds_read_b128 a[148:151], v97 offset:4096
  ds_read_b128 a[152:155], v98 offset:4096
  ds_read_b128 a[156:159], v99 offset:4096
  s_waitcnt lgkmcnt(0)
  ds_read_b64_tr_b16 a[160:161], v100 offset:0
  ds_read_b64_tr_b16 a[162:163], v100 offset:4096
  ds_read_b64_tr_b16 a[164:165], v101 offset:0
  ds_read_b64_tr_b16 a[166:167], v101 offset:4096
  ds_read_b64_tr_b16 a[168:169], v102 offset:0
  ds_read_b64_tr_b16 a[170:171], v102 offset:4096
  ds_read_b64_tr_b16 a[172:173], v103 offset:0
  ds_read_b64_tr_b16 a[174:175], v103 offset:4096
  ds_read_b64_tr_b16 a[176:177], v104 offset:0
  ds_read_b64_tr_b16 a[178:179], v104 offset:4096
  ds_read_b64_tr_b16 a[180:181], v105 offset:0
  ds_read_b64_tr_b16 a[182:183], v105 offset:4096
  ds_read_b64_tr_b16 a[184:185], v106 offset:0
  ds_read_b64_tr_b16 a[186:187], v106 offset:4096
  ds_read_b64_tr_b16 a[188:189], v107 offset:0
  ds_read_b64_tr_b16 a[190:191], v107 offset:4096
  v_mfma_f32_16x16x32_bf16 v[64:67], a[128:131], a[64:67], 0
  v_mfma_f32_16x16x32_bf16 v[64:67], a[132:135], a[68:71], v[64:67]
  v_mfma_f32_16x16x32_bf16 v[64:67], a[136:139], a[72:75], v[64:67]
  v_mfma_f32_16x16x32_bf16 v[64:67], a[140:143], a[76:79], v[64:67]
  v_mfma_f32_16x16x32_bf16 v[72:75], a[128:131], a[80:83], 0
  v_mfma_f32_16x16x32_bf16 v[72:75], a[132:135], a[84:87], v[72:75]
  v_mfma_f32_16x16x32_bf16 v[72:75], a[136:139], a[88:91], v[72:75]
  v_mfma_f32_16x16x32_bf16 v[72:75], a[140:143], a[92:95], v[72:75]
  v_mfma_f32_16x16x32_bf16 v[68:71], a[144:147], a[64:67], 0
  v_mfma_f32_16x16x32_bf16 v[68:71], a[148:151], a[68:71], v[68:71]
  v_mfma_f32_16x16x32_bf16 v[68:71], a[152:155], a[72:75], v[68:71]
  v_mfma_f32_16x16x32_bf16 v[68:71], a[156:159], a[76:79], v[68:71]
  v_mfma_f32_16x16x32_bf16 v[76:79], a[144:147], a[80:83], 0
  v_mfma_f32_16x16x32_bf16 v[76:79], a[148:151], a[84:87], v[76:79]
  v_mfma_f32_16x16x32_bf16 v[76:79], a[152:155], a[88:91], v[76:79]
  v_mfma_f32_16x16x32_bf16 v[76:79], a[156:159], a[92:95], v[76:79]
  s_nop 15
  v_max3_f32 v50, v64, v65, v66
  v_max3_f32 v50, v50, v67, v68
  v_max3_f32 v50, v50, v69, v70
  v_max_f32 v50, v50, v71
  v_mov_b32 v51, v50
  s_nop 1
  v_permlane16_swap_b32 v50, v51
  s_nop 1
  v_max_f32 v50, v50, v51
  v_mov_b32 v51, v50
  s_nop 1
  v_permlane32_swap_b32 v50, v51
  s_nop 1
  v_max_f32 v50, v50, v51
  v_max_f32 v50, v50, v48
  v_sub_f32 v52, v48, v50
  v_mov_b32 v48, v50
  v_exp_f32 v52, v52
  v_sub_f32 v64, v64, v50
  v_sub_f32 v65, v65, v50
  v_sub_f32 v66, v66, v50
  v_sub_f32 v67, v67, v50
  v_sub_f32 v68, v68, v50
  v_sub_f32 v69, v69, v50
  v_sub_f32 v70, v70, v50
  v_sub_f32 v71, v71, v50
  v_mul_f32 v32, v32, v52
  v_mul_f32 v33, v33, v52
  v_mul_f32 v34, v34, v52
  v_mul_f32 v35, v35, v52
  v_accvgpr_read_b32 v56, a0
  v_accvgpr_read_b32 v57, a1
  v_accvgpr_read_b32 v58, a2
  v_accvgpr_read_b32 v59, a3
  v_mul_f32 v56, v56, v52
  v_mul_f32 v57, v57, v52
  v_mul_f32 v58, v58, v52
  v_mul_f32 v59, v59, v52
  v_accvgpr_write_b32 a0, v56
  v_accvgpr_write_b32 a1, v57
  v_accvgpr_write_b32 a2, v58
  v_accvgpr_write_b32 a3, v59
  v_accvgpr_read_b32 v56, a4
  v_accvgpr_read_b32 v57, a5
  v_accvgpr_read_b32 v58, a6
  v_accvgpr_read_b32 v59, a7
  v_mul_f32 v56, v56, v52
  v_mul_f32 v57, v57, v52
  v_mul_f32 v58, v58, v52
  v_mul_f32 v59, v59, v52
  v_accvgpr_write_b32 a4, v56
  v_accvgpr_write_b32 a5, v57
  v_accvgpr_write_b32 a6, v58
  v_accvgpr_write_b32 a7, v59
  v_accvgpr_read_b32 v56, a8
  v_accvgpr_read_b32 v57, a9
  v_accvgpr_read_b32 v58, a10
  v_accvgpr_read_b32 v59, a11
  v_mul_f32 v56, v56, v52
  v_mul_f32 v57, v57, v52
  v_mul_f32 v58, v58, v52
  v_mul_f32 v59, v59, v52
  v_accvgpr_write_b32 a8, v56
  v_accvgpr_write_b32 a9, v57
  v_accvgpr_write_b32 a10, v58
  v_accvgpr_write_b32 a11, v59
  v_accvgpr_read_b32 v56, a12
  v_accvgpr_read_b32 v57, a13
  v_accvgpr_read_b32 v58, a14
  v_accvgpr_read_b32 v59, a15
  v_mul_f32 v56, v56, v52
  v_mul_f32 v57, v57, v52
  v_mul_f32 v58, v58, v52
  v_mul_f32 v59, v59, v52
  v_accvgpr_write_b32 a12, v56
  v_accvgpr_write_b32 a13, v57
  v_accvgpr_write_b32 a14, v58
  v_accvgpr_write_b32 a15, v59
  v_accvgpr_read_b32 v56, a16
  v_accvgpr_read_b32 v57, a17
  v_accvgpr_read_b32 v58, a18
  v_accvgpr_read_b32 v59, a19
  v_mul_f32 v56, v56, v52
  v_mul_f32 v57, v57, v52
  v_mul_f32 v58, v58, v52
  v_mul_f32 v59, v59, v52
  v_accvgpr_write_b32 a16, v56
  v_accvgpr_write_b32 a17, v57
  v_accvgpr_write_b32 a18, v58
  v_accvgpr_write_b32 a19, v59
  v_accvgpr_read_b32 v56, a20
  v_accvgpr_read_b32 v57, a21
  v_accvgpr_read_b32 v58, a22
  v_accvgpr_read_b32 v59, a23
  v_mul_f32 v56, v56, v52
  v_mul_f32 v57, v57, v52
  v_mul_f32 v58, v58, v52
  v_mul_f32 v59, v59, v52
  v_accvgpr_write_b32 a20, v56
  v_accvgpr_write_b32 a21, v57
  v_accvgpr_write_b32 a22, v58
  v_accvgpr_write_b32 a23, v59
  v_accvgpr_read_b32 v56, a24
  v_accvgpr_read_b32 v57, a25
  v_accvgpr_read_b32 v58, a26
  v_accvgpr_read_b32 v59, a27
  v_mul_f32 v56, v56, v52
  v_mul_f32 v57, v57, v52
  v_mul_f32 v58, v58, v52
  v_mul_f32 v59, v59, v52
  v_accvgpr_write_b32 a24, v56
  v_accvgpr_write_b32 a25, v57
  v_accvgpr_write_b32 a26, v58
  v_accvgpr_write_b32 a27, v59
  v_accvgpr_read_b32 v56, a28
  v_accvgpr_read_b32 v57, a29
  v_accvgpr_read_b32 v58, a30
  v_accvgpr_read_b32 v59, a31
  v_mul_f32 v56, v56, v52
  v_mul_f32 v57, v57, v52
  v_mul_f32 v58, v58, v52
  v_mul_f32 v59, v59, v52
  v_accvgpr_write_b32 a28, v56
  v_accvgpr_write_b32 a29, v57
  v_accvgpr_write_b32 a30, v58
  v_accvgpr_write_b32 a31, v59
  v_max3_f32 v50, v72, v73, v74
  v_max3_f32 v50, v50, v75, v76
  v_max3_f32 v50, v50, v77, v78
  v_max_f32 v50, v50, v79
  v_mov_b32 v51, v50
  s_nop 1
  v_permlane16_swap_b32 v50, v51
  s_nop 1
  v_max_f32 v50, v50, v51
  v_mov_b32 v51, v50
  s_nop 1
  v_permlane32_swap_b32 v50, v51
  s_nop 1
  v_max_f32 v50, v50, v51
  v_max_f32 v50, v50, v49
  v_sub_f32 v52, v49, v50
  v_mov_b32 v49, v50
  v_exp_f32 v52, v52
  v_sub_f32 v72, v72, v50
  v_sub_f32 v73, v73, v50
  v_sub_f32 v74, v74, v50
  v_sub_f32 v75, v75, v50
  v_sub_f32 v76, v76, v50
  v_sub_f32 v77, v77, v50
  v_sub_f32 v78, v78, v50
  v_sub_f32 v79, v79, v50
  v_mul_f32 v36, v36, v52
  v_mul_f32 v37, v37, v52
  v_mul_f32 v38, v38, v52
  v_mul_f32 v39, v39, v52
  v_accvgpr_read_b32 v56, a32
  v_accvgpr_read_b32 v57, a33
  v_accvgpr_read_b32 v58, a34
  v_accvgpr_read_b32 v59, a35
  v_mul_f32 v56, v56, v52
  v_mul_f32 v57, v57, v52
  v_mul_f32 v58, v58, v52
  v_mul_f32 v59, v59, v52
  v_accvgpr_write_b32 a32, v56
  v_accvgpr_write_b32 a33, v57
  v_accvgpr_write_b32 a34, v58
  v_accvgpr_write_b32 a35, v59
  v_accvgpr_read_b32 v56, a36
  v_accvgpr_read_b32 v57, a37
  v_accvgpr_read_b32 v58, a38
  v_accvgpr_read_b32 v59, a39
  v_mul_f32 v56, v56, v52
  v_mul_f32 v57, v57, v52
  v_mul_f32 v58, v58, v52
  v_mul_f32 v59, v59, v52
  v_accvgpr_write_b32 a36, v56
  v_accvgpr_write_b32 a37, v57
  v_accvgpr_write_b32 a38, v58
  v_accvgpr_write_b32 a39, v59
  v_accvgpr_read_b32 v56, a40
  v_accvgpr_read_b32 v57, a41
  v_accvgpr_read_b32 v58, a42
  v_accvgpr_read_b32 v59, a43
  v_mul_f32 v56, v56, v52
  v_mul_f32 v57, v57, v52
  v_mul_f32 v58, v58, v52
  v_mul_f32 v59, v59, v52
  v_accvgpr_write_b32 a40, v56
  v_accvgpr_write_b32 a41, v57
  v_accvgpr_write_b32 a42, v58
  v_accvgpr_write_b32 a43, v59
  v_accvgpr_read_b32 v56, a44
  v_accvgpr_read_b32 v57, a45
  v_accvgpr_read_b32 v58, a46
  v_accvgpr_read_b32 v59, a47
  v_mul_f32 v56, v56, v52
  v_mul_f32 v57, v57, v52
  v_mul_f32 v58, v58, v52
  v_mul_f32 v59, v59, v52
  v_accvgpr_write_b32 a44, v56
  v_accvgpr_write_b32 a45, v57
  v_accvgpr_write_b32 a46, v58
  v_accvgpr_write_b32 a47, v59
  v_accvgpr_read_b32 v56, a48
  v_accvgpr_read_b32 v57, a49
  v_accvgpr_read_b32 v58, a50
  v_accvgpr_read_b32 v59, a51
  v_mul_f32 v56, v56, v52
  v_mul_f32 v57, v57, v52
  v_mul_f32 v58, v58, v52
  v_mul_f32 v59, v59, v52
  v_accvgpr_write_b32 a48, v56
  v_accvgpr_write_b32 a49, v57
  v_accvgpr_write_b32 a50, v58
  v_accvgpr_write_b32 a51, v59
  v_accvgpr_read_b32 v56, a52
  v_accvgpr_read_b32 v57, a53
  v_accvgpr_read_b32 v58, a54
  v_accvgpr_read_b32 v59, a55
  v_mul_f32 v56, v56, v52
  v_mul_f32 v57, v57, v52
  v_mul_f32 v58, v58, v52
  v_mul_f32 v59, v59, v52
  v_accvgpr_write_b32 a52, v56
  v_accvgpr_write_b32 a53, v57
  v_accvgpr_write_b32 a54, v58
  v_accvgpr_write_b32 a55, v59
  v_accvgpr_read_b32 v56, a56
  v_accvgpr_read_b32 v57, a57
  v_accvgpr_read_b32 v58, a58
  v_accvgpr_read_b32 v59, a59
  v_mul_f32 v56, v56, v52
  v_mul_f32 v57, v57, v52
  v_mul_f32 v58, v58, v52
  v_mul_f32 v59, v59, v52
  v_accvgpr_write_b32 a56, v56
  v_accvgpr_write_b32 a57, v57
  v_accvgpr_write_b32 a58, v58
  v_accvgpr_write_b32 a59, v59
  v_accvgpr_read_b32 v56, a60
  v_accvgpr_read_b32 v57, a61
  v_accvgpr_read_b32 v58, a62
  v_accvgpr_read_b32 v59, a63
  v_mul_f32 v56, v56, v52
  v_mul_f32 v57, v57, v52
  v_mul_f32 v58, v58, v52
  v_mul_f32 v59, v59, v52
  v_accvgpr_write_b32 a60, v56
  v_accvgpr_write_b32 a61, v57
  v_accvgpr_write_b32 a62, v58
  v_accvgpr_write_b32 a63, v59
  v_exp_f32 v26, v64
  v_exp_f32 v27, v65
  v_exp_f32 v28, v66
  v_cvt_pk_bf16_f32 v160, v26, v27
  v_exp_f32 v29, v67
  v_exp_f32 v26, v68
  v_cvt_pk_bf16_f32 v161, v28, v29
  v_exp_f32 v27, v69
  v_exp_f32 v28, v70
  v_cvt_pk_bf16_f32 v162, v26, v27
  v_exp_f32 v29, v71
  v_exp_f32 v26, v72
  v_cvt_pk_bf16_f32 v163, v28, v29
  v_exp_f32 v27, v73
  v_exp_f32 v28, v74
  v_cvt_pk_bf16_f32 v168, v26, v27
  v_exp_f32 v29, v75
  v_exp_f32 v26, v76
  v_cvt_pk_bf16_f32 v169, v28, v29
  v_exp_f32 v27, v77
  v_exp_f32 v28, v78
  v_cvt_pk_bf16_f32 v170, v26, v27
  v_exp_f32 v29, v79
  s_nop 0
  v_cvt_pk_bf16_f32 v171, v28, v29
  s_waitcnt lgkmcnt(0)
  s_nop 1
  v_mfma_f32_16x16x32_bf16 v[32:35], a[192:195], v[160:163], v[32:35]
  v_mfma_f32_16x16x32_bf16 v[36:39], a[192:195], v[168:171], v[36:39]
  v_mfma_f32_16x16x32_bf16 a[0:3], a[160:163], v[160:163], a[0:3]
  v_mfma_f32_16x16x32_bf16 a[32:35], a[160:163], v[168:171], a[32:35]
  v_mfma_f32_16x16x32_bf16 a[4:7], a[164:167], v[160:163], a[4:7]
  v_mfma_f32_16x16x32_bf16 a[36:39], a[164:167], v[168:171], a[36:39]
  v_mfma_f32_16x16x32_bf16 a[8:11], a[168:171], v[160:163], a[8:11]
  v_mfma_f32_16x16x32_bf16 a[40:43], a[168:171], v[168:171], a[40:43]
  v_mfma_f32_16x16x32_bf16 a[12:15], a[172:175], v[160:163], a[12:15]
  v_mfma_f32_16x16x32_bf16 a[44:47], a[172:175], v[168:171], a[44:47]
  v_mfma_f32_16x16x32_bf16 a[16:19], a[176:179], v[160:163], a[16:19]
  v_mfma_f32_16x16x32_bf16 a[48:51], a[176:179], v[168:171], a[48:51]
  v_mfma_f32_16x16x32_bf16 a[20:23], a[180:183], v[160:163], a[20:23]
  v_mfma_f32_16x16x32_bf16 a[52:55], a[180:183], v[168:171], a[52:55]
  v_mfma_f32_16x16x32_bf16 a[24:27], a[184:187], v[160:163], a[24:27]
  v_mfma_f32_16x16x32_bf16 a[56:59], a[184:187], v[168:171], a[56:59]
  v_mfma_f32_16x16x32_bf16 a[28:31], a[188:191], v[160:163], a[28:31]
  v_mfma_f32_16x16x32_bf16 a[60:63], a[188:191], v[168:171], a[60:63]
  s_add_u32 s50, s50, 8192
  s_cmp_lt_u32 s50, 262144
  s_cbranch_scc1 L_slow0_loop
  v_mov_b32 v48, 0
  v_mov_b32 v52, 0
  v_mov_b32 v49, 0
  v_mov_b32 v53, 0
  v_mov_b32 v50, 0
  v_mov_b32 v54, 0
  v_mov_b32 v51, 0
  v_mov_b32 v55, 0
  v_mov_b32 v56, 0
  v_mov_b32 v60, 0
  v_mov_b32 v57, 0
  v_mov_b32 v61, 0
  v_mov_b32 v58, 0
  v_mov_b32 v62, 0
  v_mov_b32 v59, 0
  v_mov_b32 v63, 0
  v_accvgpr_write_b32 a160, 0
  v_accvgpr_write_b32 a196, 0
  v_accvgpr_write_b32 a161, 0
  v_accvgpr_write_b32 a197, 0
  v_accvgpr_write_b32 a162, 0
  v_accvgpr_write_b32 a198, 0
  v_accvgpr_write_b32 a163, 0
  v_accvgpr_write_b32 a199, 0
  v_accvgpr_write_b32 a164, 0
  v_accvgpr_write_b32 a200, 0
  v_accvgpr_write_b32 a165, 0
  v_accvgpr_write_b32 a201, 0
  v_accvgpr_write_b32 a166, 0
  v_accvgpr_write_b32 a202, 0
  v_accvgpr_write_b32 a167, 0
  v_accvgpr_write_b32 a203, 0
  v_accvgpr_write_b32 a168, 0
  v_accvgpr_write_b32 a204, 0
  v_accvgpr_write_b32 a169, 0
  v_accvgpr_write_b32 a205, 0
  v_accvgpr_write_b32 a170, 0
  v_accvgpr_write_b32 a206, 0
  v_accvgpr_write_b32 a171, 0
  v_accvgpr_write_b32 a207, 0
  v_accvgpr_write_b32 a172, 0
  v_accvgpr_write_b32 a208, 0
  v_accvgpr_write_b32 a173, 0
  v_accvgpr_write_b32 a209, 0
  v_accvgpr_write_b32 a174, 0
  v_accvgpr_write_b32 a210, 0
  v_accvgpr_write_b32 a175, 0
  v_accvgpr_write_b32 a211, 0
  v_accvgpr_write_b32 a176, 0
  v_accvgpr_write_b32 a212, 0
  v_accvgpr_write_b32 a177, 0
  v_accvgpr_write_b32 a213, 0
  v_accvgpr_write_b32 a178, 0
  v_accvgpr_write_b32 a214, 0
  v_accvgpr_write_b32 a179, 0
  v_accvgpr_write_b32 a215, 0
  v_accvgpr_write_b32 a180, 0
  v_accvgpr_write_b32 a216, 0
  v_accvgpr_write_b32 a181, 0
  v_accvgpr_write_b32 a217, 0
  v_accvgpr_write_b32 a182, 0
  v_accvgpr_write_b32 a218, 0
  v_accvgpr_write_b32 a183, 0
  v_accvgpr_write_b32 a219, 0
  v_accvgpr_write_b32 a184, 0
  v_accvgpr_write_b32 a220, 0
  v_accvgpr_write_b32 a185, 0
  v_accvgpr_write_b32 a221, 0
  v_accvgpr_write_b32 a186, 0
  v_accvgpr_write_b32 a222, 0
  v_accvgpr_write_b32 a187, 0
  v_accvgpr_write_b32 a223, 0
  v_accvgpr_write_b32 a188, 0
  v_accvgpr_write_b32 a224, 0
  v_accvgpr_write_b32 a189, 0
  v_accvgpr_write_b32 a225, 0
  v_accvgpr_write_b32 a190, 0
  v_accvgpr_write_b32 a226, 0
  v_accvgpr_write_b32 a191, 0
  v_accvgpr_write_b32 a227, 0
  s_nop 15
  s_branch L_slow0_ret
L_slow2:
  s_nop 15
  s_waitcnt vmcnt(0) lgkmcnt(0)
  v_mov_b32 v192, 0
  v_mov_b32 v193, 0
  v_mov_b32 v194, 0
  v_mov_b32 v195, 0
  v_mov_b32 v196, 0
  v_mov_b32 v197, 0
  v_mov_b32 v198, 0
  v_mov_b32 v199, 0
  v_mov_b32 v200, 0
  v_mov_b32 v201, 0
  v_mov_b32 v202, 0
  v_mov_b32 v203, 0
  v_mov_b32 v204, 0
  v_mov_b32 v205, 0
  v_mov_b32 v206, 0
  v_mov_b32 v207, 0
  v_mov_b32 v208, 0
  v_mov_b32 v209, 0
  v_mov_b32 v210, 0
  v_mov_b32 v211, 0
  v_mov_b32 v212, 0
  v_mov_b32 v213, 0
  v_mov_b32 v214, 0
  v_mov_b32 v215, 0
  v_mov_b32 v216, 0
  v_mov_b32 v217, 0
  v_mov_b32 v218, 0
  v_mov_b32 v219, 0
  v_mov_b32 v220, 0
  v_mov_b32 v221, 0
  v_mov_b32 v222, 0
  v_mov_b32 v223, 0
  v_mov_b32 v40, 0
  v_mov_b32 v41, 0
  v_mov_b32 v42, 0
  v_mov_b32 v43, 0
  v_mov_b32 v48, 0xff800000
  v_mov_b32 v224, 0
  v_mov_b32 v225, 0
  v_mov_b32 v226, 0
  v_mov_b32 v227, 0
  v_mov_b32 v228, 0
  v_mov_b32 v229, 0
  v_mov_b32 v230, 0
  v_mov_b32 v231, 0
  v_mov_b32 v232, 0
  v_mov_b32 v233, 0
  v_mov_b32 v234, 0
  v_mov_b32 v235, 0
  v_mov_b32 v236, 0
  v_mov_b32 v237, 0
  v_mov_b32 v238, 0
  v_mov_b32 v239, 0
  v_mov_b32 v240, 0
  v_mov_b32 v241, 0
  v_mov_b32 v242, 0
  v_mov_b32 v243, 0
  v_mov_b32 v244, 0
  v_mov_b32 v245, 0
  v_mov_b32 v246, 0
  v_mov_b32 v247, 0
  v_mov_b32 v248, 0
  v_mov_b32 v249, 0
  v_mov_b32 v250, 0
  v_mov_b32 v251, 0
  v_mov_b32 v252, 0
  v_mov_b32 v253, 0
  v_mov_b32 v254, 0
  v_mov_b32 v255, 0
  v_mov_b32 v44, 0
  v_mov_b32 v45, 0
  v_mov_b32 v46, 0
  v_mov_b32 v47, 0
  v_mov_b32 v49, 0xff800000
  s_sub_u32 s50, s47, 32768
  v_add_u32 v96, s50, v8
  v_add_u32 v97, s50, v9
  v_add_u32 v98, s50, v10
  v_add_u32 v99, s50, v11
  s_sub_u32 s50, s47, 57344
  v_add_u32 v100, s50, v12
  v_add_u32 v101, s50, v13
  v_add_u32 v102, s50, v14
  v_add_u32 v103, s50, v15
  v_add_u32 v104, s50, v16
  v_add_u32 v105, s50, v17
  v_add_u32 v106, s50, v18
  v_add_u32 v107, s50, v19
  s_mov_b32 s50, 0
L_slow2_loop:
  s_mov_b32 m0, s47
  s_mov_b32 s51, s50
  buffer_load_dwordx4 v20, s[20:23], s51 offen offset:0 lds
  buffer_load_dwordx4 v21, s[20:23], s51 offen offset:1024 lds
  buffer_load_dwordx4 v22, s[20:23], s51 offen offset:2048 lds
  buffer_load_dwordx4 v23, s[20:23], s51 offen offset:3072 lds
  s_add_u32 m0, s47, 4096
  s_add_u32 s51, s50, 4096
  buffer_load_dwordx4 v20, s[20:23], s51 offen offset:0 lds
  buffer_load_dwordx4 v21, s[20:23], s51 offen offset:1024 lds
  buffer_load_dwordx4 v22, s[20:23], s51 offen offset:2048 lds
  buffer_load_dwordx4 v23, s[20:23], s51 offen offset:3072 lds
  s_add_u32 m0, s47, 8192
  s_mov_b32 s51, s50
  buffer_load_dwordx4 v24, s[24:27], s51 offen offset:0 lds
  buffer_load_dwordx4 v25, s[24:27], s51 offen offset:1024 lds
  buffer_load_dwordx4 v24, s[24:27], s51 offen offset:2048 lds
  buffer_load_dwordx4 v25, s[24:27], s51 offen offset:3072 lds
  s_add_u32 m0, s47, 12288
  s_add_u32 s51, s50, 4096
  buffer_load_dwordx4 v24, s[24:27], s51 offen offset:0 lds
  buffer_load_dwordx4 v25, s[24:27], s51 offen offset:1024 lds
  buffer_load_dwordx4 v24, s[24:27], s51 offen offset:2048 lds
  buffer_load_dwordx4 v25, s[24:27], s51 offen offset:3072 lds
  s_waitcnt vmcnt(0)
  ds_read_b128 a[128:131], v96 offset:0
  ds_read_b128 a[132:135], v97 offset:0
  ds_read_b128 a[136:139], v98 offset:0
  ds_read_b128 a[140:143], v99 offset:0
  ds_read_b128 a[144:147], v96 offset:4096
  ds_read_b128 a[148:151], v97 offset:4096
  ds_read_b128 a[152:155], v98 offset:4096
  ds_read_b128 a[156:159], v99 offset:4096
  s_waitcnt lgkmcnt(0)
  ds_read_b64_tr_b16 a[160:161], v100 offset:0
  ds_read_b64_tr_b16 a[162:163], v100 offset:4096
  ds_read_b64_tr_b16 a[164:165], v101 offset:0
  ds_read_b64_tr_b16 a[166:167], v101 offset:4096
  ds_read_b64_tr_b16 a[168:169], v102 offset:0
  ds_read_b64_tr_b16 a[170:171], v102 offset:4096
  ds_read_b64_tr_b16 a[172:173], v103 offset:0
  ds_read_b64_tr_b16 a[174:175], v103 offset:4096
  ds_read_b64_tr_b16 a[176:177], v104 offset:0
  ds_read_b64_tr_b16 a[178:179], v104 offset:4096
  ds_read_b64_tr_b16 a[180:181], v105 offset:0
  ds_read_b64_tr_b16 a[182:183], v105 offset:4096
  ds_read_b64_tr_b16 a[184:185], v106 offset:0
  ds_read_b64_tr_b16 a[186:187], v106 offset:4096
  ds_read_b64_tr_b16 a[188:189], v107 offset:0
  ds_read_b64_tr_b16 a[190:191], v107 offset:4096
  v_mfma_f32_16x16x32_bf16 v[80:83], a[128:131], a[96:99], 0
  v_mfma_f32_16x16x32_bf16 v[80:83], a[132:135], a[100:103], v[80:83]
  v_mfma_f32_16x16x32_bf16 v[80:83], a[136:139], a[104:107], v[80:83]
  v_mfma_f32_16x16x32_bf16 v[80:83], a[140:143], a[108:111], v[80:83]
  v_mfma_f32_16x16x32_bf16 v[88:91], a[128:131], a[112:115], 0
  v_mfma_f32_16x16x32_bf16 v[88:91], a[132:135], a[116:119], v[88:91]
  v_mfma_f32_16x16x32_bf16 v[88:91], a[136:139], a[120:123], v[88:91]
  v_mfma_f32_16x16x32_bf16 v[88:91], a[140:143], a[124:127], v[88:91]
  v_mfma_f32_16x16x32_bf16 v[84:87], a[144:147], a[96:99], 0
  v_mfma_f32_16x16x32_bf16 v[84:87], a[148:151], a[100:103], v[84:87]
  v_mfma_f32_16x16x32_bf16 v[84:87], a[152:155], a[104:107], v[84:87]
  v_mfma_f32_16x16x32_bf16 v[84:87], a[156:159], a[108:111], v[84:87]
  v_mfma_f32_16x16x32_bf16 v[92:95], a[144:147], a[112:115], 0
  v_mfma_f32_16x16x32_bf16 v[92:95], a[148:151], a[116:119], v[92:95]
  v_mfma_f32_16x16x32_bf16 v[92:95], a[152:155], a[120:123], v[92:95]
  v_mfma_f32_16x16x32_bf16 v[92:95], a[156:159], a[124:127], v[92:95]
  s_nop 15
  v_max3_f32 v50, v80, v81, v82
  v_max3_f32 v50, v50, v83, v84
  v_max3_f32 v50, v50, v85, v86
  v_max_f32 v50, v50, v87
  v_mov_b32 v51, v50
  s_nop 1
  v_permlane16_swap_b32 v50, v51
  s_nop 1
  v_max_f32 v50, v50, v51
  v_mov_b32 v51, v50
  s_nop 1
  v_permlane32_swap_b32 v50, v51
  s_nop 1
  v_max_f32 v50, v50, v51
  v_max_f32 v50, v50, v48
  v_sub_f32 v52, v48, v50
  v_mov_b32 v48, v50
  v_exp_f32 v52, v52
  v_sub_f32 v80, v80, v50
  v_sub_f32 v81, v81, v50
  v_sub_f32 v82, v82, v50
  v_sub_f32 v83, v83, v50
  v_sub_f32 v84, v84, v50
  v_sub_f32 v85, v85, v50
  v_sub_f32 v86, v86, v50
  v_sub_f32 v87, v87, v50
  v_mul_f32 v40, v40, v52
  v_mul_f32 v41, v41, v52
  v_mul_f32 v42, v42, v52
  v_mul_f32 v43, v43, v52
  v_mul_f32 v192, v192, v52
  v_mul_f32 v193, v193, v52
  v_mul_f32 v194, v194, v52
  v_mul_f32 v195, v195, v52
  v_mul_f32 v196, v196, v52
  v_mul_f32 v197, v197, v52
  v_mul_f32 v198, v198, v52
  v_mul_f32 v199, v199, v52
  v_mul_f32 v200, v200, v52
  v_mul_f32 v201, v201, v52
  v_mul_f32 v202, v202, v52
  v_mul_f32 v203, v203, v52
  v_mul_f32 v204, v204, v52
  v_mul_f32 v205, v205, v52
  v_mul_f32 v206, v206, v52
  v_mul_f32 v207, v207, v52
  v_mul_f32 v208, v208, v52
  v_mul_f32 v209, v209, v52
  v_mul_f32 v210, v210, v52
  v_mul_f32 v211, v211, v52
  v_mul_f32 v212, v212, v52
  v_mul_f32 v213, v213, v52
  v_mul_f32 v214, v214, v52
  v_mul_f32 v215, v215, v52
  v_mul_f32 v216, v216, v52
  v_mul_f32 v217, v217, v52
  v_mul_f32 v218, v218, v52
  v_mul_f32 v219, v219, v52
  v_mul_f32 v220, v220, v52
  v_mul_f32 v221, v221, v52
  v_mul_f32 v222, v222, v52
  v_mul_f32 v223, v223, v52
  v_max3_f32 v50, v88, v89, v90
  v_max3_f32 v50, v50, v91, v92
  v_max3_f32 v50, v50, v93, v94
  v_max_f32 v50, v50, v95
  v_mov_b32 v51, v50
  s_nop 1
  v_permlane16_swap_b32 v50, v51
  s_nop 1
  v_max_f32 v50, v50, v51
  v_mov_b32 v51, v50
  s_nop 1
  v_permlane32_swap_b32 v50, v51
  s_nop 1
  v_max_f32 v50, v50, v51
  v_max_f32 v50, v50, v49
  v_sub_f32 v52, v49, v50
  v_mov_b32 v49, v50
  v_exp_f32 v52, v52
  v_sub_f32 v88, v88, v50
  v_sub_f32 v89, v89, v50
  v_sub_f32 v90, v90, v50
  v_sub_f32 v91, v91, v50
  v_sub_f32 v92, v92, v50
  v_sub_f32 v93, v93, v50
  v_sub_f32 v94, v94, v50
  v_sub_f32 v95, v95, v50
  v_mul_f32 v44, v44, v52
  v_mul_f32 v45, v45, v52
  v_mul_f32 v46, v46, v52
  v_mul_f32 v47, v47, v52
  v_mul_f32 v224, v224, v52
  v_mul_f32 v225, v225, v52
  v_mul_f32 v226, v226, v52
  v_mul_f32 v227, v227, v52
  v_mul_f32 v228, v228, v52
  v_mul_f32 v229, v229, v52
  v_mul_f32 v230, v230, v52
  v_mul_f32 v231, v231, v52
  v_mul_f32 v232, v232, v52
  v_mul_f32 v233, v233, v52
  v_mul_f32 v234, v234, v52
  v_mul_f32 v235, v235, v52
  v_mul_f32 v236, v236, v52
  v_mul_f32 v237, v237, v52
  v_mul_f32 v238, v238, v52
  v_mul_f32 v239, v239, v52
  v_mul_f32 v240, v240, v52
  v_mul_f32 v241, v241, v52
  v_mul_f32 v242, v242, v52
  v_mul_f32 v243, v243, v52
  v_mul_f32 v244, v244, v52
  v_mul_f32 v245, v245, v52
  v_mul_f32 v246, v246, v52
  v_mul_f32 v247, v247, v52
  v_mul_f32 v248, v248, v52
  v_mul_f32 v249, v249, v52
  v_mul_f32 v250, v250, v52
  v_mul_f32 v251, v251, v52
  v_mul_f32 v252, v252, v52
  v_mul_f32 v253, v253, v52
  v_mul_f32 v254, v254, v52
  v_mul_f32 v255, v255, v52
  v_exp_f32 v26, v80
  v_exp_f32 v27, v81
  v_exp_f32 v28, v82
  v_cvt_pk_bf16_f32 v176, v26, v27
  v_exp_f32 v29, v83
  v_exp_f32 v26, v84
  v_cvt_pk_bf16_f32 v177, v28, v29
  v_exp_f32 v27, v85
  v_exp_f32 v28, v86
  v_cvt_pk_bf16_f32 v178, v26, v27
  v_exp_f32 v29, v87
  v_exp_f32 v26, v88
  v_cvt_pk_bf16_f32 v179, v28, v29
  v_exp_f32 v27, v89
  v_exp_f32 v28, v90
  v_cvt_pk_bf16_f32 v184, v26, v27
  v_exp_f32 v29, v91
  v_exp_f32 v26, v92
  v_cvt_pk_bf16_f32 v185, v28, v29
  v_exp_f32 v27, v93
  v_exp_f32 v28, v94
  v_cvt_pk_bf16_f32 v186, v26, v27
  v_exp_f32 v29, v95
  s_nop 0
  v_cvt_pk_bf16_f32 v187, v28, v29
  s_waitcnt lgkmcnt(0)
  s_nop 1
  v_mfma_f32_16x16x32_bf16 v[40:43], a[192:195], v[176:179], v[40:43]
  v_mfma_f32_16x16x32_bf16 v[44:47], a[192:195], v[184:187], v[44:47]
  v_mfma_f32_16x16x32_bf16 v[192:195], a[160:163], v[176:179], v[192:195]
  v_mfma_f32_16x16x32_bf16 v[224:227], a[160:163], v[184:187], v[224:227]
  v_mfma_f32_16x16x32_bf16 v[196:199], a[164:167], v[176:179], v[196:199]
  v_mfma_f32_16x16x32_bf16 v[228:231], a[164:167], v[184:187], v[228:231]
  v_mfma_f32_16x16x32_bf16 v[200:203], a[168:171], v[176:179], v[200:203]
  v_mfma_f32_16x16x32_bf16 v[232:235], a[168:171], v[184:187], v[232:235]
  v_mfma_f32_16x16x32_bf16 v[204:207], a[172:175], v[176:179], v[204:207]
  v_mfma_f32_16x16x32_bf16 v[236:239], a[172:175], v[184:187], v[236:239]
  v_mfma_f32_16x16x32_bf16 v[208:211], a[176:179], v[176:179], v[208:211]
  v_mfma_f32_16x16x32_bf16 v[240:243], a[176:179], v[184:187], v[240:243]
  v_mfma_f32_16x16x32_bf16 v[212:215], a[180:183], v[176:179], v[212:215]
  v_mfma_f32_16x16x32_bf16 v[244:247], a[180:183], v[184:187], v[244:247]
  v_mfma_f32_16x16x32_bf16 v[216:219], a[184:187], v[176:179], v[216:219]
  v_mfma_f32_16x16x32_bf16 v[248:251], a[184:187], v[184:187], v[248:251]
  v_mfma_f32_16x16x32_bf16 v[220:223], a[188:191], v[176:179], v[220:223]
  v_mfma_f32_16x16x32_bf16 v[252:255], a[188:191], v[184:187], v[252:255]
  s_add_u32 s50, s50, 8192
  s_cmp_lt_u32 s50, 262144
  s_cbranch_scc1 L_slow2_loop
  v_mov_b32 v144, 0
  v_mov_b32 v148, 0
  v_mov_b32 v145, 0
  v_mov_b32 v149, 0
  v_mov_b32 v146, 0
  v_mov_b32 v150, 0
  v_mov_b32 v147, 0
  v_mov_b32 v151, 0
  v_mov_b32 v152, 0
  v_mov_b32 v156, 0
  v_mov_b32 v153, 0
  v_mov_b32 v157, 0
  v_mov_b32 v154, 0
  v_mov_b32 v158, 0
  v_mov_b32 v155, 0
  v_mov_b32 v159, 0
  v_accvgpr_write_b32 a160, 0
  v_accvgpr_write_b32 a196, 0
  v_accvgpr_write_b32 a161, 0
  v_accvgpr_write_b32 a197, 0
  v_accvgpr_write_b32 a162, 0
  v_accvgpr_write_b32 a198, 0
  v_accvgpr_write_b32 a163, 0
  v_accvgpr_write_b32 a199, 0
  v_accvgpr_write_b32 a164, 0
  v_accvgpr_write_b32 a200, 0
  v_accvgpr_write_b32 a165, 0
  v_accvgpr_write_b32 a201, 0
  v_accvgpr_write_b32 a166, 0
  v_accvgpr_write_b32 a202, 0
  v_accvgpr_write_b32 a167, 0
  v_accvgpr_write_b32 a203, 0
  v_accvgpr_write_b32 a168, 0
  v_accvgpr_write_b32 a204, 0
  v_accvgpr_write_b32 a169, 0
  v_accvgpr_write_b32 a205, 0
  v_accvgpr_write_b32 a170, 0
  v_accvgpr_write_b32 a206, 0
  v_accvgpr_write_b32 a171, 0
  v_accvgpr_write_b32 a207, 0
  v_accvgpr_write_b32 a172, 0
  v_accvgpr_write_b32 a208, 0
  v_accvgpr_write_b32 a173, 0
  v_accvgpr_write_b32 a209, 0
  v_accvgpr_write_b32 a174, 0
  v_accvgpr_write_b32 a210, 0
  v_accvgpr_write_b32 a175, 0
  v_accvgpr_write_b32 a211, 0
  v_accvgpr_write_b32 a176, 0
  v_accvgpr_write_b32 a212, 0
  v_accvgpr_write_b32 a177, 0
  v_accvgpr_write_b32 a213, 0
  v_accvgpr_write_b32 a178, 0
  v_accvgpr_write_b32 a214, 0
  v_accvgpr_write_b32 a179, 0
  v_accvgpr_write_b32 a215, 0
  v_accvgpr_write_b32 a180, 0
  v_accvgpr_write_b32 a216, 0
  v_accvgpr_write_b32 a181, 0
  v_accvgpr_write_b32 a217, 0
  v_accvgpr_write_b32 a182, 0
  v_accvgpr_write_b32 a218, 0
  v_accvgpr_write_b32 a183, 0
  v_accvgpr_write_b32 a219, 0
  v_accvgpr_write_b32 a184, 0
  v_accvgpr_write_b32 a220, 0
  v_accvgpr_write_b32 a185, 0
  v_accvgpr_write_b32 a221, 0
  v_accvgpr_write_b32 a186, 0
  v_accvgpr_write_b32 a222, 0
  v_accvgpr_write_b32 a187, 0
  v_accvgpr_write_b32 a223, 0
  v_accvgpr_write_b32 a188, 0
  v_accvgpr_write_b32 a224, 0
  v_accvgpr_write_b32 a189, 0
  v_accvgpr_write_b32 a225, 0
  v_accvgpr_write_b32 a190, 0
  v_accvgpr_write_b32 a226, 0
  v_accvgpr_write_b32 a191, 0
  v_accvgpr_write_b32 a227, 0
  s_nop 15
  s_branch L_slow2_ret
.fill 1956, 4, 0xbf800000
.section .rodata,"a"
.p2align 6
.amdhsa_kernel standalone__mha_softmax__near_ridge_kernel
  .amdhsa_next_free_vgpr 512
  .amdhsa_next_free_sgpr 102
  .amdhsa_accum_offset 256
  .amdhsa_group_segment_fixed_size 0
  .amdhsa_kernarg_size 48
  .amdhsa_user_sgpr_count 2
  .amdhsa_user_sgpr_kernarg_segment_ptr 1
  .amdhsa_system_sgpr_workgroup_id_x 1
  .amdhsa_dx10_clamp 0
.end_amdhsa_kernel
```
